```python
import torch

def _softmax(x, axis=-1):
    return torch.softmax(x, dim=axis)
def _gelu(x):
    return torch.nn.functional.gelu(x, approximate="tanh")
def _silu(x):
    return torch.nn.functional.silu(x)
def _sigmoid(x):
    return torch.sigmoid(x)
def _layernorm(x, axis=-1, eps=1e-5):
    m = x.mean(dim=axis, keepdim=True)
    v = x.var(dim=axis, keepdim=True, unbiased=False)
    return (x - m) / torch.sqrt(v + eps)
def _scatter_add(tgt, idx, src, axis=0):
    return tgt.clone().index_add_(axis, idx, src)
def _segment_sum(src, seg, n):
    out = torch.zeros((n,) + src.shape[1:], dtype=src.dtype)
    return out.index_add_(0, seg, src)
def _pad(x, pw):
    flat = tuple(v for pair in reversed(pw) for v in pair)
    return torch.nn.functional.pad(x, flat)

kernel_name = 'parallel_sum__grouped_kv_mqa__dense_activation_gelu__prompt'

def setup_inputs():

    _w = (lambda a: (lambda t: t.to(torch.bfloat16) if t.is_floating_point() else t)(torch.as_tensor(a)))
    def _A_setup():
        B, S, D, H = 1, 2048, 640, 32
        Dh = D // H
        return {
            "x": _w((lambda *s: torch.randn(*s, dtype=torch.bfloat16) * 0.05)(B, S, D)),
            "wq": _w((lambda *s: torch.randn(*s, dtype=torch.bfloat16) * 0.1)(D, H * Dh)),
            "wk": _w((lambda *s: torch.randn(*s, dtype=torch.bfloat16) * 0.1)(D, Dh)),
            "wv": _w((lambda *s: torch.randn(*s, dtype=torch.bfloat16) * 0.05)(D, Dh)),
            "wo": _w((lambda *s: torch.randn(*s, dtype=torch.bfloat16) * 0.05)(H * Dh, D)),
        }
    _A_in = _A_setup()

    def _B_setup():
        B, S, D, F = 1, 2048, 640, 1728
        return {
            "x": _w((lambda *s: torch.randn(*s, dtype=torch.bfloat16) * 0.05)(B, S, D)),
            "w1": _w((lambda *s: torch.randn(*s, dtype=torch.bfloat16) * 1.6)(D, F) * (D ** -0.5)),
            "b1": _w((lambda *s: torch.randn(*s, dtype=torch.bfloat16) * 1.6)(F) * 0.01),
            "w2": _w((lambda *s: torch.randn(*s, dtype=torch.bfloat16) * 1.6)(F, D) * (F ** -0.5)),
            "b2": _w((lambda *s: torch.randn(*s, dtype=torch.bfloat16) * 0.8)(D) * 0.01),
        }
    _B_in = _B_setup()

    return {
        "A_x": _A_in["x"],
        "A_wq": _A_in["wq"],
        "A_wk": _A_in["wk"],
        "A_wv": _A_in["wv"],
        "A_wo": _A_in["wo"],
        "B_x": _B_in["x"],
        "B_w1": _B_in["w1"],
        "B_b1": _B_in["b1"],
        "B_w2": _B_in["w2"],
        "B_b2": _B_in["b2"],
    }

def reference(A_x, A_wq, A_wk, A_wv, A_wo, B_x, B_w1, B_b1, B_w2, B_b2):
    def _A_ref(x, wq, wk, wv, wo):
        B, S, D = x.shape
        H = 32
        Dh = D // H
        q = (lambda x, *d: x.permute(*d))((x @ wq).reshape(B, S, H, Dh), 0, 2, 1, 3)
        k = x @ wk
        v = x @ wv
        scores = torch.einsum("bhqd,bkd->bhqk", q, k) * (Dh ** -0.5)
        p = _softmax(scores, axis=-1)
        o = torch.einsum("bhqk,bkd->bhqd", p, v)
        return (lambda x, *d: x.permute(*d))(o, 0, 2, 1, 3).reshape(B, S, H * Dh) @ wo

    def _B_ref(x, w1, b1, w2, b2):
        h = torch.einsum("bsd,df->bsf", x, w1) + b1
        h = _gelu(h)
        return torch.einsum("bsf,fd->bsd", h, w2) + b2

    x = A_x
    xn = _layernorm(x, axis=-1)
    return x + _A_ref(xn, A_wq, A_wk, A_wv, A_wo) + _B_ref(xn, B_w1, B_b1, B_w2, B_b2)
```

```asm
; @launch grid=(256,1,1) block=(512,1,1) lds=163840
.amdgcn_target "amdgcn-amd-amdhsa--gfx950"
.text
.globl parallel_sum__grouped_kv_mqa__dense_activation_gelu__prompt_kernel
.p2align 8
.type parallel_sum__grouped_kv_mqa__dense_activation_gelu__prompt_kernel,@function
parallel_sum__grouped_kv_mqa__dense_activation_gelu__prompt_kernel:
  s_cmp_ge_u32 s2, 256
  s_cbranch_scc1 L_exit
  s_load_dwordx8 s[20:27], s[0:1], 0
  s_load_dwordx8 s[28:35], s[0:1], 32
  s_load_dwordx8 s[36:43], s[0:1], 64
  s_load_dwordx2 s[44:45], s[0:1], 96
  v_lshrrev_b32 v52, 6, v0
  v_and_b32 v1, 63, v0
  v_readfirstlane_b32 s46, v52
  v_lshrrev_b32 v2, 5, v1
  v_and_b32 v3, 31, v1
  v_mov_b32 v4, 0
  v_mov_b32 v5, 0
  v_mov_b32 v6, 0
  v_mov_b32 v7, 0
  v_mov_b32 v8, 0
  v_mov_b32 v9, 0
  v_mov_b32 v10, 0
  v_mov_b32 v11, 0
  v_mov_b32 v12, 0
  v_mov_b32 v13, 0
  v_mov_b32 v14, 0
  v_mov_b32 v15, 0
  v_mov_b32 v16, 0
  v_mov_b32 v17, 0
  v_mov_b32 v18, 0
  v_mov_b32 v19, 0
  v_mov_b32 v62, 0
  s_lshr_b32 s47, s2, 1
  s_and_b32 s47, s47, 3
  s_lshl_b32 s47, s47, 3
  s_lshr_b32 s60, s2, 5
  s_add_u32 s47, s47, s60
  s_and_b32 s48, s2, 1
  s_lshl_b32 s48, s48, 2
  s_lshr_b32 s60, s2, 3
  s_and_b32 s60, s60, 3
  s_add_u32 s48, s48, s60
  s_lshl_b32 s49, s47, 6
  s_waitcnt lgkmcnt(0)
  s_mov_b32 s4, s20
  s_and_b32 s5, s21, 0xffff
  s_mov_b32 s6, 0x280000
  s_mov_b32 s7, 0x00020000
  s_mov_b32 s8, s44
  s_and_b32 s9, s45, 0xffff
  s_mov_b32 s10, 0x1000000
  s_mov_b32 s11, 0x00020000
  s_mov_b32 s16, s42
  s_and_b32 s17, s43, 0xffff
  s_mov_b32 s18, 0x100
  s_mov_b32 s19, 0x00020000
  s_cmp_lg_u32 s2, 0
  s_cbranch_scc1 L_nonce_skip
  s_cmp_lg_u32 s46, 0
  s_cbranch_scc1 L_nonce_skip
  s_memrealtime s[60:61]
  s_waitcnt lgkmcnt(0)
  s_or_b32 s60, s60, 1
  v_mov_b32 v52, s60
  v_mov_b32 v53, 0
  buffer_store_dword v52, v53, s[16:19], 0 offen sc1
L_nonce_skip:
  v_lshrrev_b32 v52, 3, v0
  v_and_b32 v53, 7, v0
  v_add_u32 v54, s49, v52
  v_mul_u32_u24 v54, 1280, v54
  v_lshl_add_u32 v54, v53, 4, v54
  buffer_load_dwordx4 v[128:131], v54, s[4:7], 0 offen offset:0
  buffer_load_dwordx4 v[132:135], v54, s[4:7], 0 offen offset:128
  buffer_load_dwordx4 v[136:139], v54, s[4:7], 0 offen offset:256
  buffer_load_dwordx4 v[140:143], v54, s[4:7], 0 offen offset:384
  buffer_load_dwordx4 v[144:147], v54, s[4:7], 0 offen offset:512
  buffer_load_dwordx4 v[148:151], v54, s[4:7], 0 offen offset:640
  buffer_load_dwordx4 v[152:155], v54, s[4:7], 0 offen offset:768
  buffer_load_dwordx4 v[156:159], v54, s[4:7], 0 offen offset:896
  buffer_load_dwordx4 v[160:163], v54, s[4:7], 0 offen offset:1024
  buffer_load_dwordx4 v[164:167], v54, s[4:7], 0 offen offset:1152
  s_cmp_lg_u32 s46, 0
  s_cbranch_scc1 L_nononce
  s_mov_b32 s16, s42
  s_and_b32 s17, s43, 0xffff
  s_mov_b32 s18, 0x100
  s_mov_b32 s19, 0x00020000
  v_mov_b32 v55, 0
  buffer_load_dword v184, v55, s[16:19], 0 offen sc1
L_nononce:
  v_mul_u32_u24 v52, 1280, v3
  v_and_b32 v53, 15, v3
  v_xor_b32 v53, v53, v2
  v_lshlrev_b32 v53, 4, v53
  v_xor_b32 v10, 0, v53
  v_add_u32 v10, v10, v52
  v_xor_b32 v11, 32, v53
  v_add_u32 v11, v11, v52
  v_xor_b32 v12, 64, v53
  v_add_u32 v12, v12, v52
  v_xor_b32 v13, 96, v53
  v_add_u32 v13, v13, v52
  v_xor_b32 v14, 128, v53
  v_add_u32 v14, v14, v52
  v_xor_b32 v15, 160, v53
  v_add_u32 v15, v15, v52
  v_xor_b32 v16, 192, v53
  v_add_u32 v16, v16, v52
  v_xor_b32 v17, 224, v53
  v_add_u32 v17, v17, v52
  v_bfe_u32 v52, v1, 2, 2
  v_and_b32 v53, 3, v1
  v_bfe_u32 v54, v1, 4, 1
  v_lshlrev_b32 v53, 3, v53
  v_lshl_add_u32 v53, v54, 5, v53
  v_lshl_add_u32 v55, v2, 3, v52
  s_mov_b32 s64, 0
  s_and_b32 s76, s46, 3
  s_mul_i32 s52, s76, 20480
  s_mul_i32 s60, s48, 160
  s_add_u32 s52, s52, s60
  s_mul_i32 s97, s76, 3072
  s_add_u32 s97, s97, 81920
  v_add_u32 v56, 0, v1
  v_mul_u32_u24 v57, 43691, v56
  v_lshrrev_b32 v57, 19, v57
  v_mul_u32_u24 v58, 12, v57
  v_sub_u32 v58, v56, v58
  v_cmp_gt_u32 vcc, 10, v58
  v_lshlrev_b32 v58, 4, v58
  v_mul_u32_u24 v59, 1280, v57
  v_add_u32 v59, v59, v58
  v_mov_b32 v60, 0x40000000
  v_cndmask_b32 v4, v60, v59, vcc
  v_bfe_u32 v61, v57, 2, 1
  v_lshlrev_b32 v61, 1, v61
  v_lshrrev_b32 v62, 3, v57
  v_add_u32 v61, v61, v62
  v_mul_u32_u24 v61, 20, v61
  v_and_b32 v62, 3, v57
  v_add3_u32 v61, v61, v62, 16
  v_mul_u32_u24 v61, 1280, v61
  v_add_u32 v61, v61, v58
  v_cndmask_b32 v7, v60, v61, vcc
  v_add_u32 v56, 64, v1
  v_mul_u32_u24 v57, 43691, v56
  v_lshrrev_b32 v57, 19, v57
  v_mul_u32_u24 v58, 12, v57
  v_sub_u32 v58, v56, v58
  v_cmp_gt_u32 vcc, 10, v58
  v_lshlrev_b32 v58, 4, v58
  v_mul_u32_u24 v59, 1280, v57
  v_add_u32 v59, v59, v58
  v_mov_b32 v60, 0x40000000
  v_cndmask_b32 v5, v60, v59, vcc
  v_bfe_u32 v61, v57, 2, 1
  v_lshlrev_b32 v61, 1, v61
  v_lshrrev_b32 v62, 3, v57
  v_add_u32 v61, v61, v62
  v_mul_u32_u24 v61, 20, v61
  v_and_b32 v62, 3, v57
  v_add3_u32 v61, v61, v62, 16
  v_mul_u32_u24 v61, 1280, v61
  v_add_u32 v61, v61, v58
  v_cndmask_b32 v8, v60, v61, vcc
  v_add_u32 v56, 128, v1
  v_mul_u32_u24 v57, 43691, v56
  v_lshrrev_b32 v57, 19, v57
  v_mul_u32_u24 v58, 12, v57
  v_sub_u32 v58, v56, v58
  v_cmp_gt_u32 vcc, 10, v58
  v_lshlrev_b32 v58, 4, v58
  v_mul_u32_u24 v59, 1280, v57
  v_add_u32 v59, v59, v58
  v_mov_b32 v60, 0x40000000
  v_cndmask_b32 v6, v60, v59, vcc
  v_bfe_u32 v61, v57, 2, 1
  v_lshlrev_b32 v61, 1, v61
  v_lshrrev_b32 v62, 3, v57
  v_add_u32 v61, v61, v62
  v_mul_u32_u24 v61, 20, v61
  v_and_b32 v62, 3, v57
  v_add3_u32 v61, v61, v62, 16
  v_mul_u32_u24 v61, 1280, v61
  v_add_u32 v61, v61, v58
  v_cndmask_b32 v9, v60, v61, vcc
  s_cmp_ge_u32 s46, 4
  s_cbranch_scc1 L_setup_B
  v_bfe_u32 v52, v1, 2, 2
  v_and_b32 v53, 3, v1
  v_bfe_u32 v54, v1, 4, 1
  v_lshlrev_b32 v53, 3, v53
  v_lshl_add_u32 v53, v54, 5, v53
  v_lshl_add_u32 v55, v2, 3, v52
  v_mul_u32_u24 v56, 192, v55
  v_add_u32 v56, v56, v53
  s_mul_i32 s60, s46, 40
  s_add_u32 s60, s60, 81920
  v_add_u32 v9, s60, v56
  s_branch L_setup_done
L_setup_B:
  s_add_u32 s52, s52, 245760
  s_cmp_lt_u32 s48, 6
  s_cbranch_scc1 L_setup_done
  s_cmp_lt_u32 s46, 6
  s_cbranch_scc1 L_setup_done
  s_sub_u32 s64, s48, 5
  s_sub_u32 s65, s46, 6
  v_bfe_u32 v52, v1, 2, 2
  v_and_b32 v53, 3, v1
  v_bfe_u32 v54, v1, 4, 1
  v_lshlrev_b32 v53, 3, v53
  v_lshl_add_u32 v53, v54, 5, v53
  v_lshl_add_u32 v55, v2, 3, v52
  v_mul_u32_u24 v56, 40, v55
  v_add_u32 v19, v56, v53
  v_add_u32 v19, 131072, v19
  s_mul_i32 s60, s65, 40960
  v_add_u32 v10, s60, v10
  v_add_u32 v11, s60, v11
  v_add_u32 v12, s60, v12
  v_add_u32 v13, s60, v13
  v_add_u32 v14, s60, v14
  v_add_u32 v15, s60, v15
  v_add_u32 v16, s60, v16
  v_add_u32 v17, s60, v17
L_setup_done:
  v_lshrrev_b32 v52, 3, v0
  v_and_b32 v53, 7, v0
  v_and_b32 v56, 15, v52
  v_xor_b32 v56, v56, v53
  v_lshlrev_b32 v56, 4, v56
  v_mul_u32_u24 v57, 1280, v52
  v_add_u32 v56, v56, v57
  v_xor_b32 v57, 128, v56
  v_mov_b32 v58, 0
  v_mov_b32 v59, 161792
  s_cmp_lg_u32 s46, 0
  s_cbranch_scc1 L_nozero
  v_lshl_add_u32 v59, v1, 2, v59
  ds_write_b32 v59, v58
  s_waitcnt lgkmcnt(0)
L_nozero:
  s_waitcnt vmcnt(0)
  s_cmp_ge_u32 s46, 3
  s_cbranch_scc1 L_pf_done
  s_lshr_b32 s60, s2, 3
  s_mul_i32 s60, s60, 20
  s_lshl_b32 s62, s46, 3
  s_add_u32 s60, s60, s62
  s_and_b32 s61, s2, 1
  s_mul_i32 s61, s61, 640
  s_mov_b32 s16, s22
  s_and_b32 s17, s23, 0xffff
  s_mov_b32 s18, 0xc8000
  s_mov_b32 s19, 0x00020000
  v_lshrrev_b32 v60, 3, v1
  v_and_b32 v61, 7, v1
  v_min_u32 v61, 5, v61
  v_add_u32 v60, s60, v60
  v_mul_u32_u24 v60, 1280, v60
  v_lshl_add_u32 v60, v61, 7, v60
  s_mov_b32 m0, 162816
  s_nop 0
  buffer_load_dword v60, s[16:19], s61 offen lds
L_pf_done:
  v_mov_b32 v62, 0x3f803f80
  v_mov_b32 v58, 0
  v_mov_b32 v59, 0
  v_mov_b32 v60, 0
  v_mov_b32 v61, 0
  v_dot2_f32_bf16 v58, v128, v62, v58
  v_dot2_f32_bf16 v59, v128, v128, v59
  v_dot2_f32_bf16 v60, v129, v62, v60
  v_dot2_f32_bf16 v61, v129, v129, v61
  v_dot2_f32_bf16 v58, v130, v62, v58
  v_dot2_f32_bf16 v59, v130, v130, v59
  v_dot2_f32_bf16 v60, v131, v62, v60
  v_dot2_f32_bf16 v61, v131, v131, v61
  v_dot2_f32_bf16 v58, v132, v62, v58
  v_dot2_f32_bf16 v59, v132, v132, v59
  v_dot2_f32_bf16 v60, v133, v62, v60
  v_dot2_f32_bf16 v61, v133, v133, v61
  v_dot2_f32_bf16 v58, v134, v62, v58
  v_dot2_f32_bf16 v59, v134, v134, v59
  v_dot2_f32_bf16 v60, v135, v62, v60
  v_dot2_f32_bf16 v61, v135, v135, v61
  v_dot2_f32_bf16 v58, v136, v62, v58
  v_dot2_f32_bf16 v59, v136, v136, v59
  v_dot2_f32_bf16 v60, v137, v62, v60
  v_dot2_f32_bf16 v61, v137, v137, v61
  v_dot2_f32_bf16 v58, v138, v62, v58
  v_dot2_f32_bf16 v59, v138, v138, v59
  v_dot2_f32_bf16 v60, v139, v62, v60
  v_dot2_f32_bf16 v61, v139, v139, v61
  v_dot2_f32_bf16 v58, v140, v62, v58
  v_dot2_f32_bf16 v59, v140, v140, v59
  v_dot2_f32_bf16 v60, v141, v62, v60
  v_dot2_f32_bf16 v61, v141, v141, v61
  v_dot2_f32_bf16 v58, v142, v62, v58
  v_dot2_f32_bf16 v59, v142, v142, v59
  v_dot2_f32_bf16 v60, v143, v62, v60
  v_dot2_f32_bf16 v61, v143, v143, v61
  v_dot2_f32_bf16 v58, v144, v62, v58
  v_dot2_f32_bf16 v59, v144, v144, v59
  v_dot2_f32_bf16 v60, v145, v62, v60
  v_dot2_f32_bf16 v61, v145, v145, v61
  v_dot2_f32_bf16 v58, v146, v62, v58
  v_dot2_f32_bf16 v59, v146, v146, v59
  v_dot2_f32_bf16 v60, v147, v62, v60
  v_dot2_f32_bf16 v61, v147, v147, v61
  v_dot2_f32_bf16 v58, v148, v62, v58
  v_dot2_f32_bf16 v59, v148, v148, v59
  v_dot2_f32_bf16 v60, v149, v62, v60
  v_dot2_f32_bf16 v61, v149, v149, v61
  v_dot2_f32_bf16 v58, v150, v62, v58
  v_dot2_f32_bf16 v59, v150, v150, v59
  v_dot2_f32_bf16 v60, v151, v62, v60
  v_dot2_f32_bf16 v61, v151, v151, v61
  v_dot2_f32_bf16 v58, v152, v62, v58
  v_dot2_f32_bf16 v59, v152, v152, v59
  v_dot2_f32_bf16 v60, v153, v62, v60
  v_dot2_f32_bf16 v61, v153, v153, v61
  v_dot2_f32_bf16 v58, v154, v62, v58
  v_dot2_f32_bf16 v59, v154, v154, v59
  v_dot2_f32_bf16 v60, v155, v62, v60
  v_dot2_f32_bf16 v61, v155, v155, v61
  v_dot2_f32_bf16 v58, v156, v62, v58
  v_dot2_f32_bf16 v59, v156, v156, v59
  v_dot2_f32_bf16 v60, v157, v62, v60
  v_dot2_f32_bf16 v61, v157, v157, v61
  v_dot2_f32_bf16 v58, v158, v62, v58
  v_dot2_f32_bf16 v59, v158, v158, v59
  v_dot2_f32_bf16 v60, v159, v62, v60
  v_dot2_f32_bf16 v61, v159, v159, v61
  v_dot2_f32_bf16 v58, v160, v62, v58
  v_dot2_f32_bf16 v59, v160, v160, v59
  v_dot2_f32_bf16 v60, v161, v62, v60
  v_dot2_f32_bf16 v61, v161, v161, v61
  v_dot2_f32_bf16 v58, v162, v62, v58
  v_dot2_f32_bf16 v59, v162, v162, v59
  v_dot2_f32_bf16 v60, v163, v62, v60
  v_dot2_f32_bf16 v61, v163, v163, v61
  v_dot2_f32_bf16 v58, v164, v62, v58
  v_dot2_f32_bf16 v59, v164, v164, v59
  v_dot2_f32_bf16 v60, v165, v62, v60
  v_dot2_f32_bf16 v61, v165, v165, v61
  v_dot2_f32_bf16 v58, v166, v62, v58
  v_dot2_f32_bf16 v59, v166, v166, v59
  v_dot2_f32_bf16 v60, v167, v62, v60
  v_dot2_f32_bf16 v61, v167, v167, v61
  s_nop 2
  v_add_f32 v58, v58, v60
  v_add_f32 v59, v59, v61
  s_nop 1
  v_add_f32_dpp v58, v58, v58 quad_perm:[1,0,3,2] row_mask:0xf bank_mask:0xf
  v_add_f32_dpp v59, v59, v59 quad_perm:[1,0,3,2] row_mask:0xf bank_mask:0xf
  s_nop 1
  v_add_f32_dpp v58, v58, v58 quad_perm:[2,3,0,1] row_mask:0xf bank_mask:0xf
  v_add_f32_dpp v59, v59, v59 quad_perm:[2,3,0,1] row_mask:0xf bank_mask:0xf
  s_nop 1
  v_add_f32_dpp v58, v58, v58 row_half_mirror row_mask:0xf bank_mask:0xf
  v_add_f32_dpp v59, v59, v59 row_half_mirror row_mask:0xf bank_mask:0xf
  v_mul_f32 v58, 0x3acccccd, v58
  v_mul_f32 v59, 0x3acccccd, v59
  v_fma_f32 v59, -v58, v58, v59
  v_max_f32 v59, 0, v59
  v_add_f32 v59, 0x3727c5ac, v59
  v_rsq_f32 v59, v59
  s_nop 0
  v_mul_f32 v58, v58, v59
  v_sub_f32 v58, 0, v58
  v_lshlrev_b32 v60, 16, v128
  v_and_b32 v61, 0xffff0000, v128
  v_lshlrev_b32 v62, 16, v129
  v_and_b32 v63, 0xffff0000, v129
  v_fma_f32 v60, v60, v59, v58
  v_fma_f32 v61, v61, v59, v58
  v_fma_f32 v62, v62, v59, v58
  v_fma_f32 v63, v63, v59, v58
  v_cvt_pk_bf16_f32 v128, v60, v61
  v_cvt_pk_bf16_f32 v129, v62, v63
  v_lshlrev_b32 v60, 16, v130
  v_and_b32 v61, 0xffff0000, v130
  v_lshlrev_b32 v62, 16, v131
  v_and_b32 v63, 0xffff0000, v131
  v_fma_f32 v60, v60, v59, v58
  v_fma_f32 v61, v61, v59, v58
  v_fma_f32 v62, v62, v59, v58
  v_fma_f32 v63, v63, v59, v58
  v_cvt_pk_bf16_f32 v130, v60, v61
  v_cvt_pk_bf16_f32 v131, v62, v63
  ds_write_b128 v56, v[128:131] offset:0
  v_lshlrev_b32 v60, 16, v132
  v_and_b32 v61, 0xffff0000, v132
  v_lshlrev_b32 v62, 16, v133
  v_and_b32 v63, 0xffff0000, v133
  v_fma_f32 v60, v60, v59, v58
  v_fma_f32 v61, v61, v59, v58
  v_fma_f32 v62, v62, v59, v58
  v_fma_f32 v63, v63, v59, v58
  v_cvt_pk_bf16_f32 v132, v60, v61
  v_cvt_pk_bf16_f32 v133, v62, v63
  v_lshlrev_b32 v60, 16, v134
  v_and_b32 v61, 0xffff0000, v134
  v_lshlrev_b32 v62, 16, v135
  v_and_b32 v63, 0xffff0000, v135
  v_fma_f32 v60, v60, v59, v58
  v_fma_f32 v61, v61, v59, v58
  v_fma_f32 v62, v62, v59, v58
  v_fma_f32 v63, v63, v59, v58
  v_cvt_pk_bf16_f32 v134, v60, v61
  v_cvt_pk_bf16_f32 v135, v62, v63
  ds_write_b128 v57, v[132:135] offset:0
  v_lshlrev_b32 v60, 16, v136
  v_and_b32 v61, 0xffff0000, v136
  v_lshlrev_b32 v62, 16, v137
  v_and_b32 v63, 0xffff0000, v137
  v_fma_f32 v60, v60, v59, v58
  v_fma_f32 v61, v61, v59, v58
  v_fma_f32 v62, v62, v59, v58
  v_fma_f32 v63, v63, v59, v58
  v_cvt_pk_bf16_f32 v136, v60, v61
  v_cvt_pk_bf16_f32 v137, v62, v63
  v_lshlrev_b32 v60, 16, v138
  v_and_b32 v61, 0xffff0000, v138
  v_lshlrev_b32 v62, 16, v139
  v_and_b32 v63, 0xffff0000, v139
  v_fma_f32 v60, v60, v59, v58
  v_fma_f32 v61, v61, v59, v58
  v_fma_f32 v62, v62, v59, v58
  v_fma_f32 v63, v63, v59, v58
  v_cvt_pk_bf16_f32 v138, v60, v61
  v_cvt_pk_bf16_f32 v139, v62, v63
  ds_write_b128 v56, v[136:139] offset:256
  v_lshlrev_b32 v60, 16, v140
  v_and_b32 v61, 0xffff0000, v140
  v_lshlrev_b32 v62, 16, v141
  v_and_b32 v63, 0xffff0000, v141
  v_fma_f32 v60, v60, v59, v58
  v_fma_f32 v61, v61, v59, v58
  v_fma_f32 v62, v62, v59, v58
  v_fma_f32 v63, v63, v59, v58
  v_cvt_pk_bf16_f32 v140, v60, v61
  v_cvt_pk_bf16_f32 v141, v62, v63
  v_lshlrev_b32 v60, 16, v142
  v_and_b32 v61, 0xffff0000, v142
  v_lshlrev_b32 v62, 16, v143
  v_and_b32 v63, 0xffff0000, v143
  v_fma_f32 v60, v60, v59, v58
  v_fma_f32 v61, v61, v59, v58
  v_fma_f32 v62, v62, v59, v58
  v_fma_f32 v63, v63, v59, v58
  v_cvt_pk_bf16_f32 v142, v60, v61
  v_cvt_pk_bf16_f32 v143, v62, v63
  ds_write_b128 v57, v[140:143] offset:256
  v_lshlrev_b32 v60, 16, v144
  v_and_b32 v61, 0xffff0000, v144
  v_lshlrev_b32 v62, 16, v145
  v_and_b32 v63, 0xffff0000, v145
  v_fma_f32 v60, v60, v59, v58
  v_fma_f32 v61, v61, v59, v58
  v_fma_f32 v62, v62, v59, v58
  v_fma_f32 v63, v63, v59, v58
  v_cvt_pk_bf16_f32 v144, v60, v61
  v_cvt_pk_bf16_f32 v145, v62, v63
  v_lshlrev_b32 v60, 16, v146
  v_and_b32 v61, 0xffff0000, v146
  v_lshlrev_b32 v62, 16, v147
  v_and_b32 v63, 0xffff0000, v147
  v_fma_f32 v60, v60, v59, v58
  v_fma_f32 v61, v61, v59, v58
  v_fma_f32 v62, v62, v59, v58
  v_fma_f32 v63, v63, v59, v58
  v_cvt_pk_bf16_f32 v146, v60, v61
  v_cvt_pk_bf16_f32 v147, v62, v63
  ds_write_b128 v56, v[144:147] offset:512
  v_lshlrev_b32 v60, 16, v148
  v_and_b32 v61, 0xffff0000, v148
  v_lshlrev_b32 v62, 16, v149
  v_and_b32 v63, 0xffff0000, v149
  v_fma_f32 v60, v60, v59, v58
  v_fma_f32 v61, v61, v59, v58
  v_fma_f32 v62, v62, v59, v58
  v_fma_f32 v63, v63, v59, v58
  v_cvt_pk_bf16_f32 v148, v60, v61
  v_cvt_pk_bf16_f32 v149, v62, v63
  v_lshlrev_b32 v60, 16, v150
  v_and_b32 v61, 0xffff0000, v150
  v_lshlrev_b32 v62, 16, v151
  v_and_b32 v63, 0xffff0000, v151
  v_fma_f32 v60, v60, v59, v58
  v_fma_f32 v61, v61, v59, v58
  v_fma_f32 v62, v62, v59, v58
  v_fma_f32 v63, v63, v59, v58
  v_cvt_pk_bf16_f32 v150, v60, v61
  v_cvt_pk_bf16_f32 v151, v62, v63
  ds_write_b128 v57, v[148:151] offset:512
  v_lshlrev_b32 v60, 16, v152
  v_and_b32 v61, 0xffff0000, v152
  v_lshlrev_b32 v62, 16, v153
  v_and_b32 v63, 0xffff0000, v153
  v_fma_f32 v60, v60, v59, v58
  v_fma_f32 v61, v61, v59, v58
  v_fma_f32 v62, v62, v59, v58
  v_fma_f32 v63, v63, v59, v58
  v_cvt_pk_bf16_f32 v152, v60, v61
  v_cvt_pk_bf16_f32 v153, v62, v63
  v_lshlrev_b32 v60, 16, v154
  v_and_b32 v61, 0xffff0000, v154
  v_lshlrev_b32 v62, 16, v155
  v_and_b32 v63, 0xffff0000, v155
  v_fma_f32 v60, v60, v59, v58
  v_fma_f32 v61, v61, v59, v58
  v_fma_f32 v62, v62, v59, v58
  v_fma_f32 v63, v63, v59, v58
  v_cvt_pk_bf16_f32 v154, v60, v61
  v_cvt_pk_bf16_f32 v155, v62, v63
  ds_write_b128 v56, v[152:155] offset:768
  v_lshlrev_b32 v60, 16, v156
  v_and_b32 v61, 0xffff0000, v156
  v_lshlrev_b32 v62, 16, v157
  v_and_b32 v63, 0xffff0000, v157
  v_fma_f32 v60, v60, v59, v58
  v_fma_f32 v61, v61, v59, v58
  v_fma_f32 v62, v62, v59, v58
  v_fma_f32 v63, v63, v59, v58
  v_cvt_pk_bf16_f32 v156, v60, v61
  v_cvt_pk_bf16_f32 v157, v62, v63
  v_lshlrev_b32 v60, 16, v158
  v_and_b32 v61, 0xffff0000, v158
  v_lshlrev_b32 v62, 16, v159
  v_and_b32 v63, 0xffff0000, v159
  v_fma_f32 v60, v60, v59, v58
  v_fma_f32 v61, v61, v59, v58
  v_fma_f32 v62, v62, v59, v58
  v_fma_f32 v63, v63, v59, v58
  v_cvt_pk_bf16_f32 v158, v60, v61
  v_cvt_pk_bf16_f32 v159, v62, v63
  ds_write_b128 v57, v[156:159] offset:768
  v_lshlrev_b32 v60, 16, v160
  v_and_b32 v61, 0xffff0000, v160
  v_lshlrev_b32 v62, 16, v161
  v_and_b32 v63, 0xffff0000, v161
  v_fma_f32 v60, v60, v59, v58
  v_fma_f32 v61, v61, v59, v58
  v_fma_f32 v62, v62, v59, v58
  v_fma_f32 v63, v63, v59, v58
  v_cvt_pk_bf16_f32 v160, v60, v61
  v_cvt_pk_bf16_f32 v161, v62, v63
  v_lshlrev_b32 v60, 16, v162
  v_and_b32 v61, 0xffff0000, v162
  v_lshlrev_b32 v62, 16, v163
  v_and_b32 v63, 0xffff0000, v163
  v_fma_f32 v60, v60, v59, v58
  v_fma_f32 v61, v61, v59, v58
  v_fma_f32 v62, v62, v59, v58
  v_fma_f32 v63, v63, v59, v58
  v_cvt_pk_bf16_f32 v162, v60, v61
  v_cvt_pk_bf16_f32 v163, v62, v63
  ds_write_b128 v56, v[160:163] offset:1024
  v_lshlrev_b32 v60, 16, v164
  v_and_b32 v61, 0xffff0000, v164
  v_lshlrev_b32 v62, 16, v165
  v_and_b32 v63, 0xffff0000, v165
  v_fma_f32 v60, v60, v59, v58
  v_fma_f32 v61, v61, v59, v58
  v_fma_f32 v62, v62, v59, v58
  v_fma_f32 v63, v63, v59, v58
  v_cvt_pk_bf16_f32 v164, v60, v61
  v_cvt_pk_bf16_f32 v165, v62, v63
  v_lshlrev_b32 v60, 16, v166
  v_and_b32 v61, 0xffff0000, v166
  v_lshlrev_b32 v62, 16, v167
  v_and_b32 v63, 0xffff0000, v167
  v_fma_f32 v60, v60, v59, v58
  v_fma_f32 v61, v61, v59, v58
  v_fma_f32 v62, v62, v59, v58
  v_fma_f32 v63, v63, v59, v58
  v_cvt_pk_bf16_f32 v166, v60, v61
  v_cvt_pk_bf16_f32 v167, v62, v63
  ds_write_b128 v57, v[164:167] offset:1024
  s_cmp_ge_u32 s46, 4
  s_cbranch_scc1 L_nofl
  s_mov_b32 s16, s22
  s_and_b32 s17, s23, 0xffff
  s_mov_b32 s18, 0xc8000
  s_mov_b32 s19, 0x00020000
  s_add_u32 m0, s97, 0
  s_nop 0
  buffer_load_dwordx4 v4, s[16:19], s52 offen lds
  s_add_u32 m0, m0, 1024
  s_nop 0
  buffer_load_dwordx4 v5, s[16:19], s52 offen lds
  s_add_u32 m0, m0, 1024
  s_nop 0
  buffer_load_dwordx4 v6, s[16:19], s52 offen lds
  s_add_u32 s52, s52, 81920
  s_add_u32 m0, s97, 12288
  s_nop 0
  buffer_load_dwordx4 v4, s[16:19], s52 offen lds
  s_add_u32 m0, m0, 1024
  s_nop 0
  buffer_load_dwordx4 v5, s[16:19], s52 offen lds
  s_add_u32 m0, m0, 1024
  s_nop 0
  buffer_load_dwordx4 v6, s[16:19], s52 offen lds
  s_add_u32 s52, s52, 81920
  s_add_u32 m0, s97, 24576
  s_nop 0
  buffer_load_dwordx4 v4, s[16:19], s52 offen lds
  s_add_u32 m0, m0, 1024
  s_nop 0
  buffer_load_dwordx4 v5, s[16:19], s52 offen lds
  s_add_u32 m0, m0, 1024
  s_nop 0
  buffer_load_dwordx4 v6, s[16:19], s52 offen lds
  s_add_u32 s52, s52, 81920
  s_cmp_lt_u32 s48, 6
  s_cbranch_scc1 L_wkvim_done
  s_cmp_eq_u32 s48, 6
  s_cselect_b32 s61, s24, s26
  s_cselect_b32 s62, s25, s27
  s_mov_b32 s12, s61
  s_and_b32 s13, s62, 0xffff
  s_mov_b32 s14, 0x6400
  s_mov_b32 s15, 0x00020000
  v_lshlrev_b32 v186, 4, v1
  s_lshl_b32 s60, s46, 10
  s_add_u32 m0, s60, 131072
  s_nop 0
  buffer_load_dwordx4 v186, s[12:15], s60 offen lds
  s_add_u32 s60, s60, 4096
  s_add_u32 m0, s60, 131072
  s_nop 0
  buffer_load_dwordx4 v186, s[12:15], s60 offen lds
  s_add_u32 s60, s60, 4096
  s_add_u32 m0, s60, 131072
  s_nop 0
  buffer_load_dwordx4 v186, s[12:15], s60 offen lds
  s_add_u32 s60, s60, 4096
  s_add_u32 m0, s60, 131072
  s_nop 0
  buffer_load_dwordx4 v186, s[12:15], s60 offen lds
  s_add_u32 s60, s60, 4096
  s_add_u32 m0, s60, 131072
  s_nop 0
  buffer_load_dwordx4 v186, s[12:15], s60 offen lds
  s_add_u32 s60, s60, 4096
  s_add_u32 m0, s60, 131072
  s_nop 0
  buffer_load_dwordx4 v186, s[12:15], s60 offen lds
  s_add_u32 s60, s60, 4096
  s_add_u32 m0, s60, 131072
  s_nop 0
  buffer_load_dwordx4 v186, s[12:15], s60 offen lds
  s_add_u32 s60, s60, 4096
L_wkvim_done:
  s_cmp_ge_u32 s46, 4
  s_cbranch_scc1 L_pf1_done
  s_lshr_b32 s60, s2, 3
  s_mul_i32 s60, s60, 20
  s_and_b32 s61, s2, 1
  s_mov_b32 s16, s32
  s_and_b32 s17, s33, 0xffff
  s_mov_b32 s18, 0x21c000
  s_mov_b32 s19, 0x00020000
  v_lshrrev_b32 v186, 4, v1
  v_and_b32 v187, 15, v1
  s_mul_i32 s62, s46, 5
  s_add_u32 s62, s62, s60
  v_add_u32 v186, s62, v186
  v_mul_u32_u24 v186, 3456, v186
  s_mul_i32 s62, s61, 1536
  v_lshlrev_b32 v188, 7, v187
  v_add_u32 v188, s62, v188
  s_lshl_b32 s62, s61, 8
  s_add_u32 s62, s62, 1536
  v_min_u32 v189, 13, v187
  v_lshlrev_b32 v189, 7, v189
  v_add_u32 v189, s62, v189
  v_cmp_gt_u32 vcc, 12, v187
  s_nop 1
  v_cndmask_b32 v188, v189, v188, vcc
  v_add_u32 v186, v186, v188
  s_mov_b32 m0, 162816
  s_mov_b32 s62, 13824
  buffer_load_dword v186, s[16:19], 0 offen lds
  s_mov_b64 exec, 0xffff
  buffer_load_dword v186, s[16:19], s62 offen lds
  s_mov_b64 exec, -1
L_pf1_done:
L_nofl:
  s_cmp_lg_u32 s46, 0
  s_cbranch_scc1 L_tag_done
  s_mov_b32 s16, s42
  s_and_b32 s17, s43, 0xffff
  s_mov_b32 s18, 0x100
  s_mov_b32 s19, 0x00020000
  s_mov_b32 s57, 0
L_tag_poll:
  v_readfirstlane_b32 s50, v184
  s_memrealtime s[60:61]
  s_waitcnt lgkmcnt(0)
  s_cmp_eq_u32 s50, 0
  s_cbranch_scc1 L_tag_again
  s_sub_u32 s60, s60, s50
  s_add_u32 s60, s60, 1
  s_cmp_lt_u32 s60, 2500
  s_cbranch_scc1 L_tag_ok
  s_cmp_ge_u32 s57, 4000
  s_cbranch_scc1 L_tag_ok
L_tag_again:
  s_add_u32 s57, s57, 1
  s_cmp_ge_u32 s57, 1000000
  s_cbranch_scc1 L_tag_to
  v_mov_b32 v55, 0
  buffer_load_dword v184, v55, s[16:19], 0 offen sc1
  s_waitcnt vmcnt(0)
  s_branch L_tag_poll
L_tag_to:
L_tag_ok:
  v_mov_b32 v55, 161816
  ds_write_b32 v55, v184
L_tag_done:
  s_waitcnt lgkmcnt(0)
  s_barrier
  v_mov_b32 v55, 161816
  ds_read_b32 v184, v55
  s_waitcnt lgkmcnt(0)
  v_readfirstlane_b32 s50, v184
  s_cmp_lt_u32 s46, 4
  s_cbranch_scc1 L_nofl2
  s_mov_b32 s16, s22
  s_and_b32 s17, s23, 0xffff
  s_mov_b32 s18, 0xc8000
  s_mov_b32 s19, 0x00020000
L_nofl2:
  s_cmp_lt_u32 s46, 4
  s_cbranch_scc1 L_jobA
  s_cmp_eq_u32 s64, 1
  s_cbranch_scc1 L_jobK
  s_cmp_eq_u32 s64, 2
  s_cbranch_scc1 L_jobV
  s_barrier
  s_add_u32 m0, s97, 36864
  s_nop 0
  buffer_load_dwordx4 v4, s[16:19], s52 offen lds
  s_add_u32 m0, m0, 1024
  s_nop 0
  buffer_load_dwordx4 v5, s[16:19], s52 offen lds
  s_add_u32 m0, m0, 1024
  s_nop 0
  buffer_load_dwordx4 v6, s[16:19], s52 offen lds
  s_add_u32 s52, s52, 81920
  s_barrier
  s_add_u32 m0, s97, 0
  s_nop 0
  buffer_load_dwordx4 v4, s[16:19], s52 offen lds
  s_add_u32 m0, m0, 1024
  s_nop 0
  buffer_load_dwordx4 v5, s[16:19], s52 offen lds
  s_add_u32 m0, m0, 1024
  s_nop 0
  buffer_load_dwordx4 v6, s[16:19], s52 offen lds
  s_add_u32 s52, s52, 81920
  s_barrier
  s_add_u32 m0, s97, 12288
  s_nop 0
  buffer_load_dwordx4 v4, s[16:19], s52 offen lds
  s_add_u32 m0, m0, 1024
  s_nop 0
  buffer_load_dwordx4 v5, s[16:19], s52 offen lds
  s_add_u32 m0, m0, 1024
  s_nop 0
  buffer_load_dwordx4 v6, s[16:19], s52 offen lds
  s_add_u32 s52, s52, 81920
  s_waitcnt vmcnt(6)
  s_barrier
  s_add_u32 m0, s97, 24576
  s_nop 0
  buffer_load_dwordx4 v4, s[16:19], s52 offen lds
  s_add_u32 m0, m0, 1024
  s_nop 0
  buffer_load_dwordx4 v5, s[16:19], s52 offen lds
  s_add_u32 m0, m0, 1024
  s_nop 0
  buffer_load_dwordx4 v6, s[16:19], s52 offen lds
  s_add_u32 s52, s52, 81920
  s_waitcnt vmcnt(6)
  s_barrier
  s_add_u32 m0, s97, 36864
  s_nop 0
  buffer_load_dwordx4 v4, s[16:19], s52 offen lds
  s_add_u32 m0, m0, 1024
  s_nop 0
  buffer_load_dwordx4 v5, s[16:19], s52 offen lds
  s_add_u32 m0, m0, 1024
  s_nop 0
  buffer_load_dwordx4 v6, s[16:19], s52 offen lds
  s_add_u32 s52, s52, 81920
  s_mul_i32 s59, s48, 6
  s_lshl_b32 s60, s76, 1
  s_add_u32 s59, s59, s60
  s_add_u32 s60, s48, 48
  s_cmp_eq_u32 s76, 3
  s_cselect_b32 s59, s60, s59
  s_mov_b32 s24, s34
  s_and_b32 s25, s35, 0xffff
  s_mov_b32 s26, 0xd80
  s_mov_b32 s27, 0x00020000
  s_lshl_b32 s61, s59, 6
  s_lshl_b32 s60, s76, 7
  s_add_u32 m0, s60, 163072
  v_lshlrev_b32 v158, 2, v1
  s_mov_b32 exec_hi, 0
  buffer_load_dword v158, s[24:27], s61 offen lds
  s_mov_b32 exec_hi, -1
  s_waitcnt vmcnt(7)
  s_barrier
  s_add_u32 m0, s97, 0
  s_nop 0
  buffer_load_dwordx4 v4, s[16:19], s52 offen lds
  s_add_u32 m0, m0, 1024
  s_nop 0
  buffer_load_dwordx4 v5, s[16:19], s52 offen lds
  s_add_u32 m0, m0, 1024
  s_nop 0
  buffer_load_dwordx4 v6, s[16:19], s52 offen lds
  s_add_u32 s52, s52, 81920
  s_waitcnt vmcnt(7)
  s_barrier
  s_add_u32 m0, s97, 12288
  s_nop 0
  buffer_load_dwordx4 v4, s[16:19], s52 offen lds
  s_add_u32 m0, m0, 1024
  s_nop 0
  buffer_load_dwordx4 v5, s[16:19], s52 offen lds
  s_add_u32 m0, m0, 1024
  s_nop 0
  buffer_load_dwordx4 v6, s[16:19], s52 offen lds
  s_add_u32 s52, s52, 81920
  s_waitcnt vmcnt(7)
  s_barrier
  s_waitcnt vmcnt(3)
  s_barrier
  s_waitcnt vmcnt(0)
  s_barrier
  s_barrier
  s_branch L_Bf
L_jobK:
  s_setprio 2
  v_mov_b32 v64, 0
  v_mov_b32 v65, 0
  v_mov_b32 v66, 0
  v_mov_b32 v67, 0
  v_mov_b32 v68, 0
  v_mov_b32 v69, 0
  v_mov_b32 v70, 0
  v_mov_b32 v71, 0
  v_mov_b32 v72, 0
  v_mov_b32 v73, 0
  v_mov_b32 v74, 0
  v_mov_b32 v75, 0
  v_mov_b32 v76, 0
  v_mov_b32 v77, 0
  v_mov_b32 v78, 0
  v_mov_b32 v79, 0
  s_barrier
  s_add_u32 m0, s97, 36864
  s_nop 0
  buffer_load_dwordx4 v4, s[16:19], s52 offen lds
  s_add_u32 m0, m0, 1024
  s_nop 0
  buffer_load_dwordx4 v5, s[16:19], s52 offen lds
  s_add_u32 m0, m0, 1024
  s_nop 0
  buffer_load_dwordx4 v6, s[16:19], s52 offen lds
  s_add_u32 s52, s52, 81920
  ds_read_b64_tr_b16 v[20:21], v19 offset:0
  ds_read_b64_tr_b16 v[22:23], v19 offset:160
  ds_read_b128 v[24:27], v10 offset:0
  ds_read_b64_tr_b16 v[28:29], v19 offset:640
  ds_read_b64_tr_b16 v[30:31], v19 offset:800
  ds_read_b128 v[32:35], v11 offset:0
  ds_read_b64_tr_b16 v[36:37], v19 offset:1280
  ds_read_b64_tr_b16 v[38:39], v19 offset:1440
  ds_read_b128 v[40:43], v12 offset:0
  s_waitcnt lgkmcnt(6)
  v_mfma_f32_32x32x16_bf16 v[64:79], v[20:23], v[24:27], v[64:79]
  ds_read_b64_tr_b16 v[20:21], v19 offset:1920
  ds_read_b64_tr_b16 v[22:23], v19 offset:2080
  ds_read_b128 v[24:27], v13 offset:0
  s_waitcnt lgkmcnt(6)
  v_mfma_f32_32x32x16_bf16 v[64:79], v[28:31], v[32:35], v[64:79]
  ds_read_b64_tr_b16 v[28:29], v19 offset:2560
  ds_read_b64_tr_b16 v[30:31], v19 offset:2720
  ds_read_b128 v[32:35], v14 offset:0
  s_waitcnt lgkmcnt(6)
  v_mfma_f32_32x32x16_bf16 v[64:79], v[36:39], v[40:43], v[64:79]
  ds_read_b64_tr_b16 v[36:37], v19 offset:3200
  ds_read_b64_tr_b16 v[38:39], v19 offset:3360
  ds_read_b128 v[40:43], v15 offset:0
  s_waitcnt lgkmcnt(6)
  v_mfma_f32_32x32x16_bf16 v[64:79], v[20:23], v[24:27], v[64:79]
  ds_read_b64_tr_b16 v[20:21], v19 offset:3840
  ds_read_b64_tr_b16 v[22:23], v19 offset:4000
  ds_read_b128 v[24:27], v16 offset:0
  s_waitcnt lgkmcnt(6)
  v_mfma_f32_32x32x16_bf16 v[64:79], v[28:31], v[32:35], v[64:79]
  ds_read_b64_tr_b16 v[28:29], v19 offset:4480
  ds_read_b64_tr_b16 v[30:31], v19 offset:4640
  ds_read_b128 v[32:35], v17 offset:0
  s_waitcnt lgkmcnt(6)
  v_mfma_f32_32x32x16_bf16 v[64:79], v[36:39], v[40:43], v[64:79]
  ds_read_b64_tr_b16 v[36:37], v19 offset:5120
  ds_read_b64_tr_b16 v[38:39], v19 offset:5280
  ds_read_b128 v[40:43], v10 offset:256
  s_waitcnt lgkmcnt(6)
  v_mfma_f32_32x32x16_bf16 v[64:79], v[20:23], v[24:27], v[64:79]
  ds_read_b64_tr_b16 v[20:21], v19 offset:5760
  ds_read_b64_tr_b16 v[22:23], v19 offset:5920
  ds_read_b128 v[24:27], v11 offset:256
  s_waitcnt lgkmcnt(6)
  v_mfma_f32_32x32x16_bf16 v[64:79], v[28:31], v[32:35], v[64:79]
  ds_read_b64_tr_b16 v[28:29], v19 offset:6400
  ds_read_b64_tr_b16 v[30:31], v19 offset:6560
  ds_read_b128 v[32:35], v12 offset:256
  s_waitcnt lgkmcnt(6)
  v_mfma_f32_32x32x16_bf16 v[64:79], v[36:39], v[40:43], v[64:79]
  ds_read_b64_tr_b16 v[36:37], v19 offset:7040
  ds_read_b64_tr_b16 v[38:39], v19 offset:7200
  ds_read_b128 v[40:43], v13 offset:256
  s_waitcnt lgkmcnt(6)
  v_mfma_f32_32x32x16_bf16 v[64:79], v[20:23], v[24:27], v[64:79]
  ds_read_b64_tr_b16 v[20:21], v19 offset:7680
  ds_read_b64_tr_b16 v[22:23], v19 offset:7840
  ds_read_b128 v[24:27], v14 offset:256
  s_waitcnt lgkmcnt(6)
  v_mfma_f32_32x32x16_bf16 v[64:79], v[28:31], v[32:35], v[64:79]
  ds_read_b64_tr_b16 v[28:29], v19 offset:8320
  ds_read_b64_tr_b16 v[30:31], v19 offset:8480
  ds_read_b128 v[32:35], v15 offset:256
  s_waitcnt lgkmcnt(6)
  v_mfma_f32_32x32x16_bf16 v[64:79], v[36:39], v[40:43], v[64:79]
  ds_read_b64_tr_b16 v[36:37], v19 offset:8960
  ds_read_b64_tr_b16 v[38:39], v19 offset:9120
  ds_read_b128 v[40:43], v16 offset:256
  s_waitcnt lgkmcnt(6)
  v_mfma_f32_32x32x16_bf16 v[64:79], v[20:23], v[24:27], v[64:79]
  ds_read_b64_tr_b16 v[20:21], v19 offset:9600
  ds_read_b64_tr_b16 v[22:23], v19 offset:9760
  ds_read_b128 v[24:27], v17 offset:256
  s_waitcnt lgkmcnt(6)
  v_mfma_f32_32x32x16_bf16 v[64:79], v[28:31], v[32:35], v[64:79]
  s_barrier
  s_add_u32 m0, s97, 0
  s_nop 0
  buffer_load_dwordx4 v4, s[16:19], s52 offen lds
  s_add_u32 m0, m0, 1024
  s_nop 0
  buffer_load_dwordx4 v5, s[16:19], s52 offen lds
  s_add_u32 m0, m0, 1024
  s_nop 0
  buffer_load_dwordx4 v6, s[16:19], s52 offen lds
  s_add_u32 s52, s52, 81920
  ds_read_b64_tr_b16 v[28:29], v19 offset:10240
  ds_read_b64_tr_b16 v[30:31], v19 offset:10400
  ds_read_b128 v[32:35], v10 offset:512
  s_waitcnt lgkmcnt(6)
  v_mfma_f32_32x32x16_bf16 v[64:79], v[36:39], v[40:43], v[64:79]
  ds_read_b64_tr_b16 v[36:37], v19 offset:10880
  ds_read_b64_tr_b16 v[38:39], v19 offset:11040
  ds_read_b128 v[40:43], v11 offset:512
  s_waitcnt lgkmcnt(6)
  v_mfma_f32_32x32x16_bf16 v[64:79], v[20:23], v[24:27], v[64:79]
  ds_read_b64_tr_b16 v[20:21], v19 offset:11520
  ds_read_b64_tr_b16 v[22:23], v19 offset:11680
  ds_read_b128 v[24:27], v12 offset:512
  s_waitcnt lgkmcnt(6)
  v_mfma_f32_32x32x16_bf16 v[64:79], v[28:31], v[32:35], v[64:79]
  ds_read_b64_tr_b16 v[28:29], v19 offset:12160
  ds_read_b64_tr_b16 v[30:31], v19 offset:12320
  ds_read_b128 v[32:35], v13 offset:512
  s_waitcnt lgkmcnt(6)
  v_mfma_f32_32x32x16_bf16 v[64:79], v[36:39], v[40:43], v[64:79]
  ds_read_b64_tr_b16 v[36:37], v19 offset:12800
  ds_read_b64_tr_b16 v[38:39], v19 offset:12960
  ds_read_b128 v[40:43], v14 offset:512
  s_waitcnt lgkmcnt(6)
  v_mfma_f32_32x32x16_bf16 v[64:79], v[20:23], v[24:27], v[64:79]
  ds_read_b64_tr_b16 v[20:21], v19 offset:13440
  ds_read_b64_tr_b16 v[22:23], v19 offset:13600
  ds_read_b128 v[24:27], v15 offset:512
  s_waitcnt lgkmcnt(6)
  v_mfma_f32_32x32x16_bf16 v[64:79], v[28:31], v[32:35], v[64:79]
  ds_read_b64_tr_b16 v[28:29], v19 offset:14080
  ds_read_b64_tr_b16 v[30:31], v19 offset:14240
  ds_read_b128 v[32:35], v16 offset:512
  s_waitcnt lgkmcnt(6)
  v_mfma_f32_32x32x16_bf16 v[64:79], v[36:39], v[40:43], v[64:79]
  ds_read_b64_tr_b16 v[36:37], v19 offset:14720
  ds_read_b64_tr_b16 v[38:39], v19 offset:14880
  ds_read_b128 v[40:43], v17 offset:512
  s_waitcnt lgkmcnt(6)
  v_mfma_f32_32x32x16_bf16 v[64:79], v[20:23], v[24:27], v[64:79]
  ds_read_b64_tr_b16 v[20:21], v19 offset:15360
  ds_read_b64_tr_b16 v[22:23], v19 offset:15520
  ds_read_b128 v[24:27], v10 offset:768
  s_waitcnt lgkmcnt(6)
  v_mfma_f32_32x32x16_bf16 v[64:79], v[28:31], v[32:35], v[64:79]
  ds_read_b64_tr_b16 v[28:29], v19 offset:16000
  ds_read_b64_tr_b16 v[30:31], v19 offset:16160
  ds_read_b128 v[32:35], v11 offset:768
  s_waitcnt lgkmcnt(6)
  v_mfma_f32_32x32x16_bf16 v[64:79], v[36:39], v[40:43], v[64:79]
  ds_read_b64_tr_b16 v[36:37], v19 offset:16640
  ds_read_b64_tr_b16 v[38:39], v19 offset:16800
  ds_read_b128 v[40:43], v12 offset:768
  s_waitcnt lgkmcnt(6)
  v_mfma_f32_32x32x16_bf16 v[64:79], v[20:23], v[24:27], v[64:79]
  ds_read_b64_tr_b16 v[20:21], v19 offset:17280
  ds_read_b64_tr_b16 v[22:23], v19 offset:17440
  ds_read_b128 v[24:27], v13 offset:768
  s_waitcnt lgkmcnt(6)
  v_mfma_f32_32x32x16_bf16 v[64:79], v[28:31], v[32:35], v[64:79]
  ds_read_b64_tr_b16 v[28:29], v19 offset:17920
  ds_read_b64_tr_b16 v[30:31], v19 offset:18080
  ds_read_b128 v[32:35], v14 offset:768
  s_waitcnt lgkmcnt(6)
  v_mfma_f32_32x32x16_bf16 v[64:79], v[36:39], v[40:43], v[64:79]
  ds_read_b64_tr_b16 v[36:37], v19 offset:18560
  ds_read_b64_tr_b16 v[38:39], v19 offset:18720
  ds_read_b128 v[40:43], v15 offset:768
  s_waitcnt lgkmcnt(6)
  v_mfma_f32_32x32x16_bf16 v[64:79], v[20:23], v[24:27], v[64:79]
  s_barrier
  s_add_u32 m0, s97, 12288
  s_nop 0
  buffer_load_dwordx4 v4, s[16:19], s52 offen lds
  s_add_u32 m0, m0, 1024
  s_nop 0
  buffer_load_dwordx4 v5, s[16:19], s52 offen lds
  s_add_u32 m0, m0, 1024
  s_nop 0
  buffer_load_dwordx4 v6, s[16:19], s52 offen lds
  s_add_u32 s52, s52, 81920
  ds_read_b64_tr_b16 v[20:21], v19 offset:19200
  ds_read_b64_tr_b16 v[22:23], v19 offset:19360
  ds_read_b128 v[24:27], v16 offset:768
  s_waitcnt lgkmcnt(6)
  v_mfma_f32_32x32x16_bf16 v[64:79], v[28:31], v[32:35], v[64:79]
  ds_read_b64_tr_b16 v[28:29], v19 offset:19840
  ds_read_b64_tr_b16 v[30:31], v19 offset:20000
  ds_read_b128 v[32:35], v17 offset:768
  s_waitcnt lgkmcnt(6)
  v_mfma_f32_32x32x16_bf16 v[64:79], v[36:39], v[40:43], v[64:79]
  ds_read_b64_tr_b16 v[36:37], v19 offset:20480
  ds_read_b64_tr_b16 v[38:39], v19 offset:20640
  ds_read_b128 v[40:43], v10 offset:1024
  s_waitcnt lgkmcnt(6)
  v_mfma_f32_32x32x16_bf16 v[64:79], v[20:23], v[24:27], v[64:79]
  ds_read_b64_tr_b16 v[20:21], v19 offset:21120
  ds_read_b64_tr_b16 v[22:23], v19 offset:21280
  ds_read_b128 v[24:27], v11 offset:1024
  s_waitcnt lgkmcnt(6)
  v_mfma_f32_32x32x16_bf16 v[64:79], v[28:31], v[32:35], v[64:79]
  ds_read_b64_tr_b16 v[28:29], v19 offset:21760
  ds_read_b64_tr_b16 v[30:31], v19 offset:21920
  ds_read_b128 v[32:35], v12 offset:1024
  s_waitcnt lgkmcnt(6)
  v_mfma_f32_32x32x16_bf16 v[64:79], v[36:39], v[40:43], v[64:79]
  ds_read_b64_tr_b16 v[36:37], v19 offset:22400
  ds_read_b64_tr_b16 v[38:39], v19 offset:22560
  ds_read_b128 v[40:43], v13 offset:1024
  s_waitcnt lgkmcnt(6)
  v_mfma_f32_32x32x16_bf16 v[64:79], v[20:23], v[24:27], v[64:79]
  ds_read_b64_tr_b16 v[20:21], v19 offset:23040
  ds_read_b64_tr_b16 v[22:23], v19 offset:23200
  ds_read_b128 v[24:27], v14 offset:1024
  s_waitcnt lgkmcnt(6)
  v_mfma_f32_32x32x16_bf16 v[64:79], v[28:31], v[32:35], v[64:79]
  ds_read_b64_tr_b16 v[28:29], v19 offset:23680
  ds_read_b64_tr_b16 v[30:31], v19 offset:23840
  ds_read_b128 v[32:35], v15 offset:1024
  s_waitcnt lgkmcnt(6)
  v_mfma_f32_32x32x16_bf16 v[64:79], v[36:39], v[40:43], v[64:79]
  ds_read_b64_tr_b16 v[36:37], v19 offset:24320
  ds_read_b64_tr_b16 v[38:39], v19 offset:24480
  ds_read_b128 v[40:43], v16 offset:1024
  s_waitcnt lgkmcnt(6)
  v_mfma_f32_32x32x16_bf16 v[64:79], v[20:23], v[24:27], v[64:79]
  ds_read_b64_tr_b16 v[20:21], v19 offset:24960
  ds_read_b64_tr_b16 v[22:23], v19 offset:25120
  ds_read_b128 v[24:27], v17 offset:1024
  s_waitcnt lgkmcnt(6)
  v_mfma_f32_32x32x16_bf16 v[64:79], v[28:31], v[32:35], v[64:79]
  s_waitcnt lgkmcnt(3)
  v_mfma_f32_32x32x16_bf16 v[64:79], v[36:39], v[40:43], v[64:79]
  s_waitcnt lgkmcnt(0)
  v_mfma_f32_32x32x16_bf16 v[64:79], v[20:23], v[24:27], v[64:79]
  s_waitcnt vmcnt(6)
  s_barrier
  s_add_u32 m0, s97, 24576
  s_nop 0
  buffer_load_dwordx4 v4, s[16:19], s52 offen lds
  s_add_u32 m0, m0, 1024
  s_nop 0
  buffer_load_dwordx4 v5, s[16:19], s52 offen lds
  s_add_u32 m0, m0, 1024
  s_nop 0
  buffer_load_dwordx4 v6, s[16:19], s52 offen lds
  s_add_u32 s52, s52, 81920
  s_nop 7
  s_nop 7
  v_cmp_eq_u32 vcc, 0, v2
  v_and_b32 v60, 0x33, v1
  v_and_b32 v61, 4, v1
  v_lshl_or_b32 v60, v61, 1, v60
  v_and_b32 v61, 8, v1
  v_lshrrev_b32 v61, 1, v61
  v_or_b32 v60, v60, v61
  v_lshlrev_b32 v61, 3, v60
  v_lshlrev_b32 v60, 4, v60
  s_lshl_b32 s60, s47, 1
  s_add_u32 s60, s60, s65
  s_mul_i32 s60, s60, 3584
  s_add_u32 s60, s60, 65536
  v_mov_b32 v55, 0x3f803f80
  v_mul_f32 v52, v64, v64
  v_fmac_f32 v52, v65, v65
  v_fmac_f32 v52, v66, v66
  v_fmac_f32 v52, v67, v67
  v_fmac_f32 v52, v68, v68
  v_fmac_f32 v52, v69, v69
  v_fmac_f32 v52, v70, v70
  v_fmac_f32 v52, v71, v71
  v_mul_f32 v53, v72, v72
  v_fmac_f32 v53, v73, v73
  v_fmac_f32 v53, v74, v74
  v_fmac_f32 v53, v75, v75
  v_cndmask_b32 v53, 0, v53, vcc
  v_add_f32 v54, v52, v53
  v_cvt_pk_bf16_f32 v64, v64, v65
  v_cvt_pk_bf16_f32 v65, v66, v67
  v_cvt_pk_bf16_f32 v66, v68, v69
  v_cvt_pk_bf16_f32 v67, v70, v71
  v_cvt_pk_bf16_f32 v68, v72, v73
  v_cvt_pk_bf16_f32 v69, v74, v75
  v_cndmask_b32 v68, v55, v68, vcc
  v_mov_b32 v55, 0x00003f80
  v_cndmask_b32 v69, v55, v69, vcc
  s_add_u32 s61, s60, 3072
  buffer_store_dwordx4 v[64:67], v60, s[8:11], s60 offen sc1
  buffer_store_dwordx2 v[68:69], v61, s[8:11], s61 offen sc1
  v_mov_b32 v53, v54
  s_nop 1
  v_permlane32_swap_b32 v54, v53
  s_nop 1
  v_add_f32 v54, v54, v53
  s_nop 1
  v_max_f32_dpp v54, v54, v54 quad_perm:[1,0,3,2] row_mask:0xf bank_mask:0xf
  s_nop 1
  v_max_f32_dpp v54, v54, v54 quad_perm:[2,3,0,1] row_mask:0xf bank_mask:0xf
  s_nop 1
  v_max_f32_dpp v54, v54, v54 row_half_mirror row_mask:0xf bank_mask:0xf
  s_nop 1
  v_max_f32_dpp v54, v54, v54 row_mirror row_mask:0xf bank_mask:0xf
  s_nop 1
  v_mov_b32 v55, v54
  s_nop 1
  v_permlane16_swap_b32 v54, v55
  s_nop 1
  v_max_f32 v100, v54, v55
  s_waitcnt vmcnt(6)
  s_barrier
  s_add_u32 m0, s97, 36864
  s_nop 0
  buffer_load_dwordx4 v4, s[16:19], s52 offen lds
  s_add_u32 m0, m0, 1024
  s_nop 0
  buffer_load_dwordx4 v5, s[16:19], s52 offen lds
  s_add_u32 m0, m0, 1024
  s_nop 0
  buffer_load_dwordx4 v6, s[16:19], s52 offen lds
  s_add_u32 s52, s52, 81920
  s_mul_i32 s59, s48, 6
  s_lshl_b32 s60, s76, 1
  s_add_u32 s59, s59, s60
  s_add_u32 s60, s48, 48
  s_cmp_eq_u32 s76, 3
  s_cselect_b32 s59, s60, s59
  s_mov_b32 s24, s34
  s_and_b32 s25, s35, 0xffff
  s_mov_b32 s26, 0xd80
  s_mov_b32 s27, 0x00020000
  s_lshl_b32 s61, s59, 6
  s_lshl_b32 s60, s76, 7
  s_add_u32 m0, s60, 163072
  v_lshlrev_b32 v158, 2, v1
  s_mov_b32 exec_hi, 0
  buffer_load_dword v158, s[24:27], s61 offen lds
  s_mov_b32 exec_hi, -1
  s_waitcnt vmcnt(7)
  s_barrier
  s_add_u32 m0, s97, 0
  s_nop 0
  buffer_load_dwordx4 v4, s[16:19], s52 offen lds
  s_add_u32 m0, m0, 1024
  s_nop 0
  buffer_load_dwordx4 v5, s[16:19], s52 offen lds
  s_add_u32 m0, m0, 1024
  s_nop 0
  buffer_load_dwordx4 v6, s[16:19], s52 offen lds
  s_add_u32 s52, s52, 81920
  s_waitcnt vmcnt(0)
  s_lshl_b32 s60, s47, 1
  s_add_u32 s60, s60, s65
  s_lshl_b32 s60, s60, 7
  s_add_u32 s60, s60, 11534336
  v_mov_b32 v62, s50
  v_readfirstlane_b32 s61, v100
  v_lshlrev_b32 v61, 14, v1
  s_nop 0
  v_mov_b32 v63, s61
  s_mov_b64 exec, 0xff
  buffer_store_dwordx2 v[62:63], v61, s[8:11], s60 offen sc1
  s_mov_b64 exec, -1
  s_waitcnt vmcnt(7)
  s_barrier
  s_add_u32 m0, s97, 12288
  s_nop 0
  buffer_load_dwordx4 v4, s[16:19], s52 offen lds
  s_add_u32 m0, m0, 1024
  s_nop 0
  buffer_load_dwordx4 v5, s[16:19], s52 offen lds
  s_add_u32 m0, m0, 1024
  s_nop 0
  buffer_load_dwordx4 v6, s[16:19], s52 offen lds
  s_add_u32 s52, s52, 81920
  s_waitcnt vmcnt(7)
  s_barrier
  s_waitcnt vmcnt(3)
  s_barrier
  s_waitcnt vmcnt(0)
  s_barrier
  s_barrier
  s_branch L_Bf
L_jobV:
  s_setprio 2
  v_mov_b32 v64, 0
  v_mov_b32 v65, 0
  v_mov_b32 v66, 0
  v_mov_b32 v67, 0
  v_mov_b32 v68, 0
  v_mov_b32 v69, 0
  v_mov_b32 v70, 0
  v_mov_b32 v71, 0
  v_mov_b32 v72, 0
  v_mov_b32 v73, 0
  v_mov_b32 v74, 0
  v_mov_b32 v75, 0
  v_mov_b32 v76, 0
  v_mov_b32 v77, 0
  v_mov_b32 v78, 0
  v_mov_b32 v79, 0
  s_barrier
  s_add_u32 m0, s97, 36864
  s_nop 0
  buffer_load_dwordx4 v4, s[16:19], s52 offen lds
  s_add_u32 m0, m0, 1024
  s_nop 0
  buffer_load_dwordx4 v5, s[16:19], s52 offen lds
  s_add_u32 m0, m0, 1024
  s_nop 0
  buffer_load_dwordx4 v6, s[16:19], s52 offen lds
  s_add_u32 s52, s52, 81920
  ds_read_b64_tr_b16 v[20:21], v19 offset:0
  ds_read_b64_tr_b16 v[22:23], v19 offset:160
  ds_read_b128 v[24:27], v10 offset:0
  ds_read_b64_tr_b16 v[28:29], v19 offset:640
  ds_read_b64_tr_b16 v[30:31], v19 offset:800
  ds_read_b128 v[32:35], v11 offset:0
  ds_read_b64_tr_b16 v[36:37], v19 offset:1280
  ds_read_b64_tr_b16 v[38:39], v19 offset:1440
  ds_read_b128 v[40:43], v12 offset:0
  s_waitcnt lgkmcnt(6)
  v_mfma_f32_32x32x16_bf16 v[64:79], v[24:27], v[20:23], v[64:79]
  ds_read_b64_tr_b16 v[20:21], v19 offset:1920
  ds_read_b64_tr_b16 v[22:23], v19 offset:2080
  ds_read_b128 v[24:27], v13 offset:0
  s_waitcnt lgkmcnt(6)
  v_mfma_f32_32x32x16_bf16 v[64:79], v[32:35], v[28:31], v[64:79]
  ds_read_b64_tr_b16 v[28:29], v19 offset:2560
  ds_read_b64_tr_b16 v[30:31], v19 offset:2720
  ds_read_b128 v[32:35], v14 offset:0
  s_waitcnt lgkmcnt(6)
  v_mfma_f32_32x32x16_bf16 v[64:79], v[40:43], v[36:39], v[64:79]
  ds_read_b64_tr_b16 v[36:37], v19 offset:3200
  ds_read_b64_tr_b16 v[38:39], v19 offset:3360
  ds_read_b128 v[40:43], v15 offset:0
  s_waitcnt lgkmcnt(6)
  v_mfma_f32_32x32x16_bf16 v[64:79], v[24:27], v[20:23], v[64:79]
  ds_read_b64_tr_b16 v[20:21], v19 offset:3840
  ds_read_b64_tr_b16 v[22:23], v19 offset:4000
  ds_read_b128 v[24:27], v16 offset:0
  s_waitcnt lgkmcnt(6)
  v_mfma_f32_32x32x16_bf16 v[64:79], v[32:35], v[28:31], v[64:79]
  ds_read_b64_tr_b16 v[28:29], v19 offset:4480
  ds_read_b64_tr_b16 v[30:31], v19 offset:4640
  ds_read_b128 v[32:35], v17 offset:0
  s_waitcnt lgkmcnt(6)
  v_mfma_f32_32x32x16_bf16 v[64:79], v[40:43], v[36:39], v[64:79]
  ds_read_b64_tr_b16 v[36:37], v19 offset:5120
  ds_read_b64_tr_b16 v[38:39], v19 offset:5280
  ds_read_b128 v[40:43], v10 offset:256
  s_waitcnt lgkmcnt(6)
  v_mfma_f32_32x32x16_bf16 v[64:79], v[24:27], v[20:23], v[64:79]
  ds_read_b64_tr_b16 v[20:21], v19 offset:5760
  ds_read_b64_tr_b16 v[22:23], v19 offset:5920
  ds_read_b128 v[24:27], v11 offset:256
  s_waitcnt lgkmcnt(6)
  v_mfma_f32_32x32x16_bf16 v[64:79], v[32:35], v[28:31], v[64:79]
  ds_read_b64_tr_b16 v[28:29], v19 offset:6400
  ds_read_b64_tr_b16 v[30:31], v19 offset:6560
  ds_read_b128 v[32:35], v12 offset:256
  s_waitcnt lgkmcnt(6)
  v_mfma_f32_32x32x16_bf16 v[64:79], v[40:43], v[36:39], v[64:79]
  ds_read_b64_tr_b16 v[36:37], v19 offset:7040
  ds_read_b64_tr_b16 v[38:39], v19 offset:7200
  ds_read_b128 v[40:43], v13 offset:256
  s_waitcnt lgkmcnt(6)
  v_mfma_f32_32x32x16_bf16 v[64:79], v[24:27], v[20:23], v[64:79]
  ds_read_b64_tr_b16 v[20:21], v19 offset:7680
  ds_read_b64_tr_b16 v[22:23], v19 offset:7840
  ds_read_b128 v[24:27], v14 offset:256
  s_waitcnt lgkmcnt(6)
  v_mfma_f32_32x32x16_bf16 v[64:79], v[32:35], v[28:31], v[64:79]
  ds_read_b64_tr_b16 v[28:29], v19 offset:8320
  ds_read_b64_tr_b16 v[30:31], v19 offset:8480
  ds_read_b128 v[32:35], v15 offset:256
  s_waitcnt lgkmcnt(6)
  v_mfma_f32_32x32x16_bf16 v[64:79], v[40:43], v[36:39], v[64:79]
  ds_read_b64_tr_b16 v[36:37], v19 offset:8960
  ds_read_b64_tr_b16 v[38:39], v19 offset:9120
  ds_read_b128 v[40:43], v16 offset:256
  s_waitcnt lgkmcnt(6)
  v_mfma_f32_32x32x16_bf16 v[64:79], v[24:27], v[20:23], v[64:79]
  ds_read_b64_tr_b16 v[20:21], v19 offset:9600
  ds_read_b64_tr_b16 v[22:23], v19 offset:9760
  ds_read_b128 v[24:27], v17 offset:256
  s_waitcnt lgkmcnt(6)
  v_mfma_f32_32x32x16_bf16 v[64:79], v[32:35], v[28:31], v[64:79]
  s_barrier
  s_add_u32 m0, s97, 0
  s_nop 0
  buffer_load_dwordx4 v4, s[16:19], s52 offen lds
  s_add_u32 m0, m0, 1024
  s_nop 0
  buffer_load_dwordx4 v5, s[16:19], s52 offen lds
  s_add_u32 m0, m0, 1024
  s_nop 0
  buffer_load_dwordx4 v6, s[16:19], s52 offen lds
  s_add_u32 s52, s52, 81920
  ds_read_b64_tr_b16 v[28:29], v19 offset:10240
  ds_read_b64_tr_b16 v[30:31], v19 offset:10400
  ds_read_b128 v[32:35], v10 offset:512
  s_waitcnt lgkmcnt(6)
  v_mfma_f32_32x32x16_bf16 v[64:79], v[40:43], v[36:39], v[64:79]
  ds_read_b64_tr_b16 v[36:37], v19 offset:10880
  ds_read_b64_tr_b16 v[38:39], v19 offset:11040
  ds_read_b128 v[40:43], v11 offset:512
  s_waitcnt lgkmcnt(6)
  v_mfma_f32_32x32x16_bf16 v[64:79], v[24:27], v[20:23], v[64:79]
  ds_read_b64_tr_b16 v[20:21], v19 offset:11520
  ds_read_b64_tr_b16 v[22:23], v19 offset:11680
  ds_read_b128 v[24:27], v12 offset:512
  s_waitcnt lgkmcnt(6)
  v_mfma_f32_32x32x16_bf16 v[64:79], v[32:35], v[28:31], v[64:79]
  ds_read_b64_tr_b16 v[28:29], v19 offset:12160
  ds_read_b64_tr_b16 v[30:31], v19 offset:12320
  ds_read_b128 v[32:35], v13 offset:512
  s_waitcnt lgkmcnt(6)
  v_mfma_f32_32x32x16_bf16 v[64:79], v[40:43], v[36:39], v[64:79]
  ds_read_b64_tr_b16 v[36:37], v19 offset:12800
  ds_read_b64_tr_b16 v[38:39], v19 offset:12960
  ds_read_b128 v[40:43], v14 offset:512
  s_waitcnt lgkmcnt(6)
  v_mfma_f32_32x32x16_bf16 v[64:79], v[24:27], v[20:23], v[64:79]
  ds_read_b64_tr_b16 v[20:21], v19 offset:13440
  ds_read_b64_tr_b16 v[22:23], v19 offset:13600
  ds_read_b128 v[24:27], v15 offset:512
  s_waitcnt lgkmcnt(6)
  v_mfma_f32_32x32x16_bf16 v[64:79], v[32:35], v[28:31], v[64:79]
  ds_read_b64_tr_b16 v[28:29], v19 offset:14080
  ds_read_b64_tr_b16 v[30:31], v19 offset:14240
  ds_read_b128 v[32:35], v16 offset:512
  s_waitcnt lgkmcnt(6)
  v_mfma_f32_32x32x16_bf16 v[64:79], v[40:43], v[36:39], v[64:79]
  ds_read_b64_tr_b16 v[36:37], v19 offset:14720
  ds_read_b64_tr_b16 v[38:39], v19 offset:14880
  ds_read_b128 v[40:43], v17 offset:512
  s_waitcnt lgkmcnt(6)
  v_mfma_f32_32x32x16_bf16 v[64:79], v[24:27], v[20:23], v[64:79]
  ds_read_b64_tr_b16 v[20:21], v19 offset:15360
  ds_read_b64_tr_b16 v[22:23], v19 offset:15520
  ds_read_b128 v[24:27], v10 offset:768
  s_waitcnt lgkmcnt(6)
  v_mfma_f32_32x32x16_bf16 v[64:79], v[32:35], v[28:31], v[64:79]
  ds_read_b64_tr_b16 v[28:29], v19 offset:16000
  ds_read_b64_tr_b16 v[30:31], v19 offset:16160
  ds_read_b128 v[32:35], v11 offset:768
  s_waitcnt lgkmcnt(6)
  v_mfma_f32_32x32x16_bf16 v[64:79], v[40:43], v[36:39], v[64:79]
  ds_read_b64_tr_b16 v[36:37], v19 offset:16640
  ds_read_b64_tr_b16 v[38:39], v19 offset:16800
  ds_read_b128 v[40:43], v12 offset:768
  s_waitcnt lgkmcnt(6)
  v_mfma_f32_32x32x16_bf16 v[64:79], v[24:27], v[20:23], v[64:79]
  ds_read_b64_tr_b16 v[20:21], v19 offset:17280
  ds_read_b64_tr_b16 v[22:23], v19 offset:17440
  ds_read_b128 v[24:27], v13 offset:768
  s_waitcnt lgkmcnt(6)
  v_mfma_f32_32x32x16_bf16 v[64:79], v[32:35], v[28:31], v[64:79]
  ds_read_b64_tr_b16 v[28:29], v19 offset:17920
  ds_read_b64_tr_b16 v[30:31], v19 offset:18080
  ds_read_b128 v[32:35], v14 offset:768
  s_waitcnt lgkmcnt(6)
  v_mfma_f32_32x32x16_bf16 v[64:79], v[40:43], v[36:39], v[64:79]
  ds_read_b64_tr_b16 v[36:37], v19 offset:18560
  ds_read_b64_tr_b16 v[38:39], v19 offset:18720
  ds_read_b128 v[40:43], v15 offset:768
  s_waitcnt lgkmcnt(6)
  v_mfma_f32_32x32x16_bf16 v[64:79], v[24:27], v[20:23], v[64:79]
  s_barrier
  s_add_u32 m0, s97, 12288
  s_nop 0
  buffer_load_dwordx4 v4, s[16:19], s52 offen lds
  s_add_u32 m0, m0, 1024
  s_nop 0
  buffer_load_dwordx4 v5, s[16:19], s52 offen lds
  s_add_u32 m0, m0, 1024
  s_nop 0
  buffer_load_dwordx4 v6, s[16:19], s52 offen lds
  s_add_u32 s52, s52, 81920
  ds_read_b64_tr_b16 v[20:21], v19 offset:19200
  ds_read_b64_tr_b16 v[22:23], v19 offset:19360
  ds_read_b128 v[24:27], v16 offset:768
  s_waitcnt lgkmcnt(6)
  v_mfma_f32_32x32x16_bf16 v[64:79], v[32:35], v[28:31], v[64:79]
  ds_read_b64_tr_b16 v[28:29], v19 offset:19840
  ds_read_b64_tr_b16 v[30:31], v19 offset:20000
  ds_read_b128 v[32:35], v17 offset:768
  s_waitcnt lgkmcnt(6)
  v_mfma_f32_32x32x16_bf16 v[64:79], v[40:43], v[36:39], v[64:79]
  ds_read_b64_tr_b16 v[36:37], v19 offset:20480
  ds_read_b64_tr_b16 v[38:39], v19 offset:20640
  ds_read_b128 v[40:43], v10 offset:1024
  s_waitcnt lgkmcnt(6)
  v_mfma_f32_32x32x16_bf16 v[64:79], v[24:27], v[20:23], v[64:79]
  ds_read_b64_tr_b16 v[20:21], v19 offset:21120
  ds_read_b64_tr_b16 v[22:23], v19 offset:21280
  ds_read_b128 v[24:27], v11 offset:1024
  s_waitcnt lgkmcnt(6)
  v_mfma_f32_32x32x16_bf16 v[64:79], v[32:35], v[28:31], v[64:79]
  ds_read_b64_tr_b16 v[28:29], v19 offset:21760
  ds_read_b64_tr_b16 v[30:31], v19 offset:21920
  ds_read_b128 v[32:35], v12 offset:1024
  s_waitcnt lgkmcnt(6)
  v_mfma_f32_32x32x16_bf16 v[64:79], v[40:43], v[36:39], v[64:79]
  ds_read_b64_tr_b16 v[36:37], v19 offset:22400
  ds_read_b64_tr_b16 v[38:39], v19 offset:22560
  ds_read_b128 v[40:43], v13 offset:1024
  s_waitcnt lgkmcnt(6)
  v_mfma_f32_32x32x16_bf16 v[64:79], v[24:27], v[20:23], v[64:79]
  ds_read_b64_tr_b16 v[20:21], v19 offset:23040
  ds_read_b64_tr_b16 v[22:23], v19 offset:23200
  ds_read_b128 v[24:27], v14 offset:1024
  s_waitcnt lgkmcnt(6)
  v_mfma_f32_32x32x16_bf16 v[64:79], v[32:35], v[28:31], v[64:79]
  ds_read_b64_tr_b16 v[28:29], v19 offset:23680
  ds_read_b64_tr_b16 v[30:31], v19 offset:23840
  ds_read_b128 v[32:35], v15 offset:1024
  s_waitcnt lgkmcnt(6)
  v_mfma_f32_32x32x16_bf16 v[64:79], v[40:43], v[36:39], v[64:79]
  ds_read_b64_tr_b16 v[36:37], v19 offset:24320
  ds_read_b64_tr_b16 v[38:39], v19 offset:24480
  ds_read_b128 v[40:43], v16 offset:1024
  s_waitcnt lgkmcnt(6)
  v_mfma_f32_32x32x16_bf16 v[64:79], v[24:27], v[20:23], v[64:79]
  ds_read_b64_tr_b16 v[20:21], v19 offset:24960
  ds_read_b64_tr_b16 v[22:23], v19 offset:25120
  ds_read_b128 v[24:27], v17 offset:1024
  s_waitcnt lgkmcnt(6)
  v_mfma_f32_32x32x16_bf16 v[64:79], v[32:35], v[28:31], v[64:79]
  s_waitcnt lgkmcnt(3)
  v_mfma_f32_32x32x16_bf16 v[64:79], v[40:43], v[36:39], v[64:79]
  s_waitcnt lgkmcnt(0)
  v_mfma_f32_32x32x16_bf16 v[64:79], v[24:27], v[20:23], v[64:79]
  s_waitcnt vmcnt(6)
  s_barrier
  s_add_u32 m0, s97, 24576
  s_nop 0
  buffer_load_dwordx4 v4, s[16:19], s52 offen lds
  s_add_u32 m0, m0, 1024
  s_nop 0
  buffer_load_dwordx4 v5, s[16:19], s52 offen lds
  s_add_u32 m0, m0, 1024
  s_nop 0
  buffer_load_dwordx4 v6, s[16:19], s52 offen lds
  s_add_u32 s52, s52, 81920
  s_nop 7
  s_nop 7
  v_cmp_eq_u32 vcc, 20, v3
  v_cmp_gt_u32 s[62:63], 20, v3
  v_mov_b32 v52, 0x3f803f80
  v_cndmask_b32 v52, 0, v52, vcc
  v_lshlrev_b32 v60, 4, v1
  s_lshl_b32 s60, s47, 1
  s_add_u32 s60, s60, s65
  s_mul_i32 s60, s60, 3584
  s_add_u32 s60, s60, 65536
  v_cvt_pk_bf16_f32 v64, v64, v65
  v_cvt_pk_bf16_f32 v65, v66, v67
  v_cvt_pk_bf16_f32 v66, v68, v69
  v_cvt_pk_bf16_f32 v67, v70, v71
  v_cvt_pk_bf16_f32 v68, v72, v73
  v_cvt_pk_bf16_f32 v69, v74, v75
  v_cvt_pk_bf16_f32 v70, v76, v77
  v_cvt_pk_bf16_f32 v71, v78, v79
  v_cndmask_b32 v64, v52, v64, s[62:63]
  v_cndmask_b32 v65, v52, v65, s[62:63]
  v_cndmask_b32 v66, v52, v66, s[62:63]
  v_cndmask_b32 v67, v52, v67, s[62:63]
  v_cndmask_b32 v68, v52, v68, s[62:63]
  v_cndmask_b32 v69, v52, v69, s[62:63]
  v_cndmask_b32 v70, v52, v70, s[62:63]
  v_cndmask_b32 v71, v52, v71, s[62:63]
  s_add_u32 s61, s60, 1024
  buffer_store_dwordx4 v[64:67], v60, s[8:11], s61 offen sc1
  s_add_u32 s61, s60, 2048
  buffer_store_dwordx4 v[68:71], v60, s[8:11], s61 offen sc1
  v_mov_b32 v100, 0
  s_waitcnt vmcnt(6)
  s_barrier
  s_add_u32 m0, s97, 36864
  s_nop 0
  buffer_load_dwordx4 v4, s[16:19], s52 offen lds
  s_add_u32 m0, m0, 1024
  s_nop 0
  buffer_load_dwordx4 v5, s[16:19], s52 offen lds
  s_add_u32 m0, m0, 1024
  s_nop 0
  buffer_load_dwordx4 v6, s[16:19], s52 offen lds
  s_add_u32 s52, s52, 81920
  s_mul_i32 s59, s48, 6
  s_lshl_b32 s60, s76, 1
  s_add_u32 s59, s59, s60
  s_add_u32 s60, s48, 48
  s_cmp_eq_u32 s76, 3
  s_cselect_b32 s59, s60, s59
  s_mov_b32 s24, s34
  s_and_b32 s25, s35, 0xffff
  s_mov_b32 s26, 0xd80
  s_mov_b32 s27, 0x00020000
  s_lshl_b32 s61, s59, 6
  s_lshl_b32 s60, s76, 7
  s_add_u32 m0, s60, 163072
  v_lshlrev_b32 v158, 2, v1
  s_mov_b32 exec_hi, 0
  buffer_load_dword v158, s[24:27], s61 offen lds
  s_mov_b32 exec_hi, -1
  s_waitcnt vmcnt(7)
  s_barrier
  s_add_u32 m0, s97, 0
  s_nop 0
  buffer_load_dwordx4 v4, s[16:19], s52 offen lds
  s_add_u32 m0, m0, 1024
  s_nop 0
  buffer_load_dwordx4 v5, s[16:19], s52 offen lds
  s_add_u32 m0, m0, 1024
  s_nop 0
  buffer_load_dwordx4 v6, s[16:19], s52 offen lds
  s_add_u32 s52, s52, 81920
  s_waitcnt vmcnt(0)
  s_lshl_b32 s60, s47, 1
  s_add_u32 s60, s60, s65
  s_lshl_b32 s60, s60, 7
  s_add_u32 s60, s60, 11542528
  v_mov_b32 v62, s50
  v_readfirstlane_b32 s61, v100
  v_lshlrev_b32 v61, 14, v1
  s_nop 0
  v_mov_b32 v63, s61
  s_mov_b64 exec, 0xff
  buffer_store_dwordx2 v[62:63], v61, s[8:11], s60 offen sc1
  s_mov_b64 exec, -1
  s_waitcnt vmcnt(7)
  s_barrier
  s_add_u32 m0, s97, 12288
  s_nop 0
  buffer_load_dwordx4 v4, s[16:19], s52 offen lds
  s_add_u32 m0, m0, 1024
  s_nop 0
  buffer_load_dwordx4 v5, s[16:19], s52 offen lds
  s_add_u32 m0, m0, 1024
  s_nop 0
  buffer_load_dwordx4 v6, s[16:19], s52 offen lds
  s_add_u32 s52, s52, 81920
  s_waitcnt vmcnt(7)
  s_barrier
  s_waitcnt vmcnt(3)
  s_barrier
  s_waitcnt vmcnt(0)
  s_barrier
  s_barrier
L_Bf:
  s_setprio 2
  s_cmp_eq_u32 s76, 3
  s_cbranch_scc1 L_Bf3
  v_bfe_u32 v52, v1, 2, 2
  v_and_b32 v53, 3, v1
  v_bfe_u32 v54, v1, 4, 1
  v_lshlrev_b32 v53, 3, v53
  v_lshl_add_u32 v53, v54, 5, v53
  v_lshl_add_u32 v55, v2, 3, v52
  v_mul_u32_u24 v60, 1280, v3
  v_and_b32 v61, 15, v3
  v_xor_b32 v61, v61, v2
  v_lshlrev_b32 v61, 4, v61
  v_xor_b32 v10, 0, v61
  v_add_u32 v10, v10, v60
  v_xor_b32 v11, 32, v61
  v_add_u32 v11, v11, v60
  v_xor_b32 v12, 64, v61
  v_add_u32 v12, v12, v60
  v_xor_b32 v13, 96, v61
  v_add_u32 v13, v13, v60
  v_xor_b32 v14, 128, v61
  v_add_u32 v14, v14, v60
  v_xor_b32 v15, 160, v61
  v_add_u32 v15, v15, v60
  v_xor_b32 v16, 192, v61
  v_add_u32 v16, v16, v60
  v_xor_b32 v17, 224, v61
  v_add_u32 v17, v17, v60
  s_mov_b32 s12, s32
  s_and_b32 s13, s33, 0xffff
  s_mov_b32 s14, 0x21c000
  s_mov_b32 s15, 0x00020000
  s_lshl_b32 s51, s59, 6
  s_mov_b32 s53, 55296
  s_mul_i32 s56, s76, 12288
  s_add_u32 s56, s56, 81920
  s_add_u32 s52, s51, 27648
  v_lshrrev_b32 v56, 3, v1
  v_mul_u32_u24 v56, 3456, v56
  v_and_b32 v57, 7, v1
  v_lshlrev_b32 v58, 2, v54
  v_xor_b32 v57, v57, v58
  v_lshl_add_u32 v18, v57, 4, v56
  v_lshl_add_u32 v19, v55, 7, v53
  v_bfe_u32 v56, v52, 1, 1
  v_lshl_add_u32 v19, v56, 6, v19
  v_xor_b32 v56, 64, v19
  v_add_u32 v19, s56, v19
  v_add_u32 v62, s56, v56
  s_add_u32 m0, s56, 0
  s_nop 0
  buffer_load_dwordx4 v18, s[12:15], s51 offen lds
  s_add_u32 s51, s51, s53
  s_add_u32 m0, s56, 1024
  s_nop 0
  buffer_load_dwordx4 v18, s[12:15], s52 offen lds
  s_add_u32 s52, s52, s53
  s_add_u32 m0, s56, 2048
  s_nop 0
  buffer_load_dwordx4 v18, s[12:15], s51 offen lds
  s_add_u32 s51, s51, s53
  s_add_u32 m0, s56, 3072
  s_nop 0
  buffer_load_dwordx4 v18, s[12:15], s52 offen lds
  s_add_u32 s52, s52, s53
  s_add_u32 m0, s56, 4096
  s_nop 0
  buffer_load_dwordx4 v18, s[12:15], s51 offen lds
  s_add_u32 s51, s51, s53
  s_add_u32 m0, s56, 5120
  s_nop 0
  buffer_load_dwordx4 v18, s[12:15], s52 offen lds
  s_add_u32 s52, s52, s53
  s_add_u32 m0, s56, 6144
  s_nop 0
  buffer_load_dwordx4 v18, s[12:15], s51 offen lds
  s_add_u32 s51, s51, s53
  s_add_u32 m0, s56, 7168
  s_nop 0
  buffer_load_dwordx4 v18, s[12:15], s52 offen lds
  s_add_u32 s52, s52, s53
  s_add_u32 m0, s56, 8192
  s_nop 0
  buffer_load_dwordx4 v18, s[12:15], s51 offen lds
  s_add_u32 s51, s51, s53
  s_add_u32 m0, s56, 9216
  s_nop 0
  buffer_load_dwordx4 v18, s[12:15], s52 offen lds
  s_add_u32 s52, s52, s53
  s_add_u32 m0, s56, 10240
  s_nop 0
  buffer_load_dwordx4 v18, s[12:15], s51 offen lds
  s_add_u32 s51, s51, s53
  s_add_u32 m0, s56, 11264
  s_nop 0
  buffer_load_dwordx4 v18, s[12:15], s52 offen lds
  s_add_u32 s52, s52, s53
  s_lshl_b32 s60, s76, 7
  s_add_u32 s60, s60, 163072
  v_lshlrev_b32 v158, 3, v2
  v_add_u32 v158, s60, v158
  ds_read_b64 v[128:129], v158 offset:0
  ds_read_b64 v[130:131], v158 offset:16
  ds_read_b64 v[132:133], v158 offset:32
  ds_read_b64 v[134:135], v158 offset:48
  ds_read_b64 v[136:137], v158 offset:64
  ds_read_b64 v[138:139], v158 offset:80
  ds_read_b64 v[140:141], v158 offset:96
  ds_read_b64 v[142:143], v158 offset:112
  s_waitcnt lgkmcnt(0)
  v_lshlrev_b32 v64, 16, v128
  v_and_b32 v65, 0xffff0000, v128
  v_lshlrev_b32 v80, 16, v128
  v_and_b32 v81, 0xffff0000, v128
  v_lshlrev_b32 v66, 16, v129
  v_and_b32 v67, 0xffff0000, v129
  v_lshlrev_b32 v82, 16, v129
  v_and_b32 v83, 0xffff0000, v129
  v_lshlrev_b32 v68, 16, v130
  v_and_b32 v69, 0xffff0000, v130
  v_lshlrev_b32 v84, 16, v130
  v_and_b32 v85, 0xffff0000, v130
  v_lshlrev_b32 v70, 16, v131
  v_and_b32 v71, 0xffff0000, v131
  v_lshlrev_b32 v86, 16, v131
  v_and_b32 v87, 0xffff0000, v131
  v_lshlrev_b32 v72, 16, v132
  v_and_b32 v73, 0xffff0000, v132
  v_lshlrev_b32 v88, 16, v132
  v_and_b32 v89, 0xffff0000, v132
  v_lshlrev_b32 v74, 16, v133
  v_and_b32 v75, 0xffff0000, v133
  v_lshlrev_b32 v90, 16, v133
  v_and_b32 v91, 0xffff0000, v133
  v_lshlrev_b32 v76, 16, v134
  v_and_b32 v77, 0xffff0000, v134
  v_lshlrev_b32 v92, 16, v134
  v_and_b32 v93, 0xffff0000, v134
  v_lshlrev_b32 v78, 16, v135
  v_and_b32 v79, 0xffff0000, v135
  v_lshlrev_b32 v94, 16, v135
  v_and_b32 v95, 0xffff0000, v135
  v_lshlrev_b32 v96, 16, v136
  v_and_b32 v97, 0xffff0000, v136
  v_lshlrev_b32 v112, 16, v136
  v_and_b32 v113, 0xffff0000, v136
  v_lshlrev_b32 v98, 16, v137
  v_and_b32 v99, 0xffff0000, v137
  v_lshlrev_b32 v114, 16, v137
  v_and_b32 v115, 0xffff0000, v137
  v_lshlrev_b32 v100, 16, v138
  v_and_b32 v101, 0xffff0000, v138
  v_lshlrev_b32 v116, 16, v138
  v_and_b32 v117, 0xffff0000, v138
  v_lshlrev_b32 v102, 16, v139
  v_and_b32 v103, 0xffff0000, v139
  v_lshlrev_b32 v118, 16, v139
  v_and_b32 v119, 0xffff0000, v139
  v_lshlrev_b32 v104, 16, v140
  v_and_b32 v105, 0xffff0000, v140
  v_lshlrev_b32 v120, 16, v140
  v_and_b32 v121, 0xffff0000, v140
  v_lshlrev_b32 v106, 16, v141
  v_and_b32 v107, 0xffff0000, v141
  v_lshlrev_b32 v122, 16, v141
  v_and_b32 v123, 0xffff0000, v141
  v_lshlrev_b32 v108, 16, v142
  v_and_b32 v109, 0xffff0000, v142
  v_lshlrev_b32 v124, 16, v142
  v_and_b32 v125, 0xffff0000, v142
  v_lshlrev_b32 v110, 16, v143
  v_and_b32 v111, 0xffff0000, v143
  v_lshlrev_b32 v126, 16, v143
  v_and_b32 v127, 0xffff0000, v143
  s_waitcnt vmcnt(10)
  ds_read_b128 v[36:39], v10 offset:0
  ds_read_b128 v[40:43], v10 offset:40960
  ds_read_b64_tr_b16 v[20:21], v19 offset:0
  ds_read_b64_tr_b16 v[22:23], v19 offset:512
  ds_read_b64_tr_b16 v[24:25], v62 offset:0
  ds_read_b64_tr_b16 v[26:27], v62 offset:512
  s_waitcnt lgkmcnt(0)
  s_waitcnt vmcnt(8)
  v_mfma_f32_32x32x16_bf16 v[64:79], v[20:23], v[36:39], v[64:79]
  ds_read_b128 v[44:47], v11 offset:0
  ds_read_b128 v[48:51], v11 offset:40960
  s_add_u32 m0, s56, 0
  s_nop 0
  buffer_load_dwordx4 v18, s[12:15], s51 offen lds
  s_add_u32 s51, s51, s53
  v_mfma_f32_32x32x16_bf16 v[80:95], v[20:23], v[40:43], v[80:95]
  ds_read_b64_tr_b16 v[28:29], v19 offset:2048
  ds_read_b64_tr_b16 v[30:31], v19 offset:2560
  v_mfma_f32_32x32x16_bf16 v[96:111], v[24:27], v[36:39], v[96:111]
  ds_read_b64_tr_b16 v[32:33], v62 offset:2048
  ds_read_b64_tr_b16 v[34:35], v62 offset:2560
  s_add_u32 m0, s56, 1024
  s_nop 0
  buffer_load_dwordx4 v18, s[12:15], s52 offen lds
  s_add_u32 s52, s52, s53
  v_mfma_f32_32x32x16_bf16 v[112:127], v[24:27], v[40:43], v[112:127]
  s_waitcnt lgkmcnt(0)
  s_waitcnt vmcnt(8)
  v_mfma_f32_32x32x16_bf16 v[64:79], v[28:31], v[44:47], v[64:79]
  ds_read_b128 v[36:39], v12 offset:0
  ds_read_b128 v[40:43], v12 offset:40960
  s_add_u32 m0, s56, 2048
  s_nop 0
  buffer_load_dwordx4 v18, s[12:15], s51 offen lds
  s_add_u32 s51, s51, s53
  v_mfma_f32_32x32x16_bf16 v[80:95], v[28:31], v[48:51], v[80:95]
  ds_read_b64_tr_b16 v[20:21], v19 offset:4096
  ds_read_b64_tr_b16 v[22:23], v19 offset:4608
  v_mfma_f32_32x32x16_bf16 v[96:111], v[32:35], v[44:47], v[96:111]
  ds_read_b64_tr_b16 v[24:25], v62 offset:4096
  ds_read_b64_tr_b16 v[26:27], v62 offset:4608
  s_add_u32 m0, s56, 3072
  s_nop 0
  buffer_load_dwordx4 v18, s[12:15], s52 offen lds
  s_add_u32 s52, s52, s53
  v_mfma_f32_32x32x16_bf16 v[112:127], v[32:35], v[48:51], v[112:127]
  s_waitcnt lgkmcnt(0)
  s_waitcnt vmcnt(8)
  v_mfma_f32_32x32x16_bf16 v[64:79], v[20:23], v[36:39], v[64:79]
  ds_read_b128 v[44:47], v13 offset:0
  ds_read_b128 v[48:51], v13 offset:40960
  s_add_u32 m0, s56, 4096
  s_nop 0
  buffer_load_dwordx4 v18, s[12:15], s51 offen lds
  s_add_u32 s51, s51, s53
  v_mfma_f32_32x32x16_bf16 v[80:95], v[20:23], v[40:43], v[80:95]
  ds_read_b64_tr_b16 v[28:29], v19 offset:6144
  ds_read_b64_tr_b16 v[30:31], v19 offset:6656
  v_mfma_f32_32x32x16_bf16 v[96:111], v[24:27], v[36:39], v[96:111]
  ds_read_b64_tr_b16 v[32:33], v62 offset:6144
  ds_read_b64_tr_b16 v[34:35], v62 offset:6656
  s_add_u32 m0, s56, 5120
  s_nop 0
  buffer_load_dwordx4 v18, s[12:15], s52 offen lds
  s_add_u32 s52, s52, s53
  v_mfma_f32_32x32x16_bf16 v[112:127], v[24:27], v[40:43], v[112:127]
  s_waitcnt lgkmcnt(0)
  s_waitcnt vmcnt(8)
  v_mfma_f32_32x32x16_bf16 v[64:79], v[28:31], v[44:47], v[64:79]
  ds_read_b128 v[36:39], v14 offset:0
  ds_read_b128 v[40:43], v14 offset:40960
  s_add_u32 m0, s56, 6144
  s_nop 0
  buffer_load_dwordx4 v18, s[12:15], s51 offen lds
  s_add_u32 s51, s51, s53
  v_mfma_f32_32x32x16_bf16 v[80:95], v[28:31], v[48:51], v[80:95]
  ds_read_b64_tr_b16 v[20:21], v19 offset:8192
  ds_read_b64_tr_b16 v[22:23], v19 offset:8704
  v_mfma_f32_32x32x16_bf16 v[96:111], v[32:35], v[44:47], v[96:111]
  ds_read_b64_tr_b16 v[24:25], v62 offset:8192
  ds_read_b64_tr_b16 v[26:27], v62 offset:8704
  s_add_u32 m0, s56, 7168
  s_nop 0
  buffer_load_dwordx4 v18, s[12:15], s52 offen lds
  s_add_u32 s52, s52, s53
  v_mfma_f32_32x32x16_bf16 v[112:127], v[32:35], v[48:51], v[112:127]
  s_waitcnt lgkmcnt(0)
  s_waitcnt vmcnt(8)
  v_mfma_f32_32x32x16_bf16 v[64:79], v[20:23], v[36:39], v[64:79]
  ds_read_b128 v[44:47], v15 offset:0
  ds_read_b128 v[48:51], v15 offset:40960
  s_add_u32 m0, s56, 8192
  s_nop 0
  buffer_load_dwordx4 v18, s[12:15], s51 offen lds
  s_add_u32 s51, s51, s53
  v_mfma_f32_32x32x16_bf16 v[80:95], v[20:23], v[40:43], v[80:95]
  ds_read_b64_tr_b16 v[28:29], v19 offset:10240
  ds_read_b64_tr_b16 v[30:31], v19 offset:10752
  v_mfma_f32_32x32x16_bf16 v[96:111], v[24:27], v[36:39], v[96:111]
  ds_read_b64_tr_b16 v[32:33], v62 offset:10240
  ds_read_b64_tr_b16 v[34:35], v62 offset:10752
  s_add_u32 m0, s56, 9216
  s_nop 0
  buffer_load_dwordx4 v18, s[12:15], s52 offen lds
  s_add_u32 s52, s52, s53
  v_mfma_f32_32x32x16_bf16 v[112:127], v[24:27], v[40:43], v[112:127]
  s_waitcnt lgkmcnt(0)
  s_waitcnt vmcnt(8)
  v_mfma_f32_32x32x16_bf16 v[64:79], v[28:31], v[44:47], v[64:79]
  ds_read_b128 v[36:39], v16 offset:0
  ds_read_b128 v[40:43], v16 offset:40960
  s_add_u32 m0, s56, 10240
  s_nop 0
  buffer_load_dwordx4 v18, s[12:15], s51 offen lds
  s_add_u32 s51, s51, s53
  v_mfma_f32_32x32x16_bf16 v[80:95], v[28:31], v[48:51], v[80:95]
  ds_read_b64_tr_b16 v[20:21], v19 offset:0
  ds_read_b64_tr_b16 v[22:23], v19 offset:512
  v_mfma_f32_32x32x16_bf16 v[96:111], v[32:35], v[44:47], v[96:111]
  ds_read_b64_tr_b16 v[24:25], v62 offset:0
  ds_read_b64_tr_b16 v[26:27], v62 offset:512
  s_add_u32 m0, s56, 11264
  s_nop 0
  buffer_load_dwordx4 v18, s[12:15], s52 offen lds
  s_add_u32 s52, s52, s53
  v_mfma_f32_32x32x16_bf16 v[112:127], v[32:35], v[48:51], v[112:127]
  s_waitcnt lgkmcnt(0)
  s_waitcnt vmcnt(8)
  v_mfma_f32_32x32x16_bf16 v[64:79], v[20:23], v[36:39], v[64:79]
  ds_read_b128 v[44:47], v17 offset:0
  ds_read_b128 v[48:51], v17 offset:40960
  s_add_u32 m0, s56, 0
  s_nop 0
  buffer_load_dwordx4 v18, s[12:15], s51 offen lds
  s_add_u32 s51, s51, s53
  v_mfma_f32_32x32x16_bf16 v[80:95], v[20:23], v[40:43], v[80:95]
  ds_read_b64_tr_b16 v[28:29], v19 offset:2048
  ds_read_b64_tr_b16 v[30:31], v19 offset:2560
  v_mfma_f32_32x32x16_bf16 v[96:111], v[24:27], v[36:39], v[96:111]
  ds_read_b64_tr_b16 v[32:33], v62 offset:2048
  ds_read_b64_tr_b16 v[34:35], v62 offset:2560
  s_add_u32 m0, s56, 1024
  s_nop 0
  buffer_load_dwordx4 v18, s[12:15], s52 offen lds
  s_add_u32 s52, s52, s53
  v_mfma_f32_32x32x16_bf16 v[112:127], v[24:27], v[40:43], v[112:127]
  s_waitcnt lgkmcnt(0)
  s_waitcnt vmcnt(8)
  v_mfma_f32_32x32x16_bf16 v[64:79], v[28:31], v[44:47], v[64:79]
  ds_read_b128 v[36:39], v10 offset:256
  ds_read_b128 v[40:43], v10 offset:41216
  s_add_u32 m0, s56, 2048
  s_nop 0
  buffer_load_dwordx4 v18, s[12:15], s51 offen lds
  s_add_u32 s51, s51, s53
  v_mfma_f32_32x32x16_bf16 v[80:95], v[28:31], v[48:51], v[80:95]
  ds_read_b64_tr_b16 v[20:21], v19 offset:4096
  ds_read_b64_tr_b16 v[22:23], v19 offset:4608
  v_mfma_f32_32x32x16_bf16 v[96:111], v[32:35], v[44:47], v[96:111]
  ds_read_b64_tr_b16 v[24:25], v62 offset:4096
  ds_read_b64_tr_b16 v[26:27], v62 offset:4608
  s_add_u32 m0, s56, 3072
  s_nop 0
  buffer_load_dwordx4 v18, s[12:15], s52 offen lds
  s_add_u32 s52, s52, s53
  v_mfma_f32_32x32x16_bf16 v[112:127], v[32:35], v[48:51], v[112:127]
  s_waitcnt lgkmcnt(0)
  s_waitcnt vmcnt(8)
  v_mfma_f32_32x32x16_bf16 v[64:79], v[20:23], v[36:39], v[64:79]
  ds_read_b128 v[44:47], v11 offset:256
  ds_read_b128 v[48:51], v11 offset:41216
  s_add_u32 m0, s56, 4096
  s_nop 0
  buffer_load_dwordx4 v18, s[12:15], s51 offen lds
  s_add_u32 s51, s51, s53
  v_mfma_f32_32x32x16_bf16 v[80:95], v[20:23], v[40:43], v[80:95]
  ds_read_b64_tr_b16 v[28:29], v19 offset:6144
  ds_read_b64_tr_b16 v[30:31], v19 offset:6656
  v_mfma_f32_32x32x16_bf16 v[96:111], v[24:27], v[36:39], v[96:111]
  ds_read_b64_tr_b16 v[32:33], v62 offset:6144
  ds_read_b64_tr_b16 v[34:35], v62 offset:6656
  s_add_u32 m0, s56, 5120
  s_nop 0
  buffer_load_dwordx4 v18, s[12:15], s52 offen lds
  s_add_u32 s52, s52, s53
  v_mfma_f32_32x32x16_bf16 v[112:127], v[24:27], v[40:43], v[112:127]
  s_waitcnt lgkmcnt(0)
  s_waitcnt vmcnt(8)
  v_mfma_f32_32x32x16_bf16 v[64:79], v[28:31], v[44:47], v[64:79]
  ds_read_b128 v[36:39], v12 offset:256
  ds_read_b128 v[40:43], v12 offset:41216
  s_add_u32 m0, s56, 6144
  s_nop 0
  buffer_load_dwordx4 v18, s[12:15], s51 offen lds
  s_add_u32 s51, s51, s53
  v_mfma_f32_32x32x16_bf16 v[80:95], v[28:31], v[48:51], v[80:95]
  ds_read_b64_tr_b16 v[20:21], v19 offset:8192
  ds_read_b64_tr_b16 v[22:23], v19 offset:8704
  v_mfma_f32_32x32x16_bf16 v[96:111], v[32:35], v[44:47], v[96:111]
  ds_read_b64_tr_b16 v[24:25], v62 offset:8192
  ds_read_b64_tr_b16 v[26:27], v62 offset:8704
  s_add_u32 m0, s56, 7168
  s_nop 0
  buffer_load_dwordx4 v18, s[12:15], s52 offen lds
  s_add_u32 s52, s52, s53
  v_mfma_f32_32x32x16_bf16 v[112:127], v[32:35], v[48:51], v[112:127]
  s_waitcnt lgkmcnt(0)
  s_waitcnt vmcnt(8)
  v_mfma_f32_32x32x16_bf16 v[64:79], v[20:23], v[36:39], v[64:79]
  ds_read_b128 v[44:47], v13 offset:256
  ds_read_b128 v[48:51], v13 offset:41216
  s_add_u32 m0, s56, 8192
  s_nop 0
  buffer_load_dwordx4 v18, s[12:15], s51 offen lds
  s_add_u32 s51, s51, s53
  v_mfma_f32_32x32x16_bf16 v[80:95], v[20:23], v[40:43], v[80:95]
  ds_read_b64_tr_b16 v[28:29], v19 offset:10240
  ds_read_b64_tr_b16 v[30:31], v19 offset:10752
  v_mfma_f32_32x32x16_bf16 v[96:111], v[24:27], v[36:39], v[96:111]
  ds_read_b64_tr_b16 v[32:33], v62 offset:10240
  ds_read_b64_tr_b16 v[34:35], v62 offset:10752
  s_add_u32 m0, s56, 9216
  s_nop 0
  buffer_load_dwordx4 v18, s[12:15], s52 offen lds
  s_add_u32 s52, s52, s53
  v_mfma_f32_32x32x16_bf16 v[112:127], v[24:27], v[40:43], v[112:127]
  s_waitcnt lgkmcnt(0)
  s_waitcnt vmcnt(8)
  v_mfma_f32_32x32x16_bf16 v[64:79], v[28:31], v[44:47], v[64:79]
  ds_read_b128 v[36:39], v14 offset:256
  ds_read_b128 v[40:43], v14 offset:41216
  s_add_u32 m0, s56, 10240
  s_nop 0
  buffer_load_dwordx4 v18, s[12:15], s51 offen lds
  s_add_u32 s51, s51, s53
  v_mfma_f32_32x32x16_bf16 v[80:95], v[28:31], v[48:51], v[80:95]
  ds_read_b64_tr_b16 v[20:21], v19 offset:0
  ds_read_b64_tr_b16 v[22:23], v19 offset:512
  v_mfma_f32_32x32x16_bf16 v[96:111], v[32:35], v[44:47], v[96:111]
  ds_read_b64_tr_b16 v[24:25], v62 offset:0
  ds_read_b64_tr_b16 v[26:27], v62 offset:512
  s_add_u32 m0, s56, 11264
  s_nop 0
  buffer_load_dwordx4 v18, s[12:15], s52 offen lds
  s_add_u32 s52, s52, s53
  v_mfma_f32_32x32x16_bf16 v[112:127], v[32:35], v[48:51], v[112:127]
  s_waitcnt lgkmcnt(0)
  s_waitcnt vmcnt(8)
  v_mfma_f32_32x32x16_bf16 v[64:79], v[20:23], v[36:39], v[64:79]
  ds_read_b128 v[44:47], v15 offset:256
  ds_read_b128 v[48:51], v15 offset:41216
  s_add_u32 m0, s56, 0
  s_nop 0
  buffer_load_dwordx4 v18, s[12:15], s51 offen lds
  s_add_u32 s51, s51, s53
  v_mfma_f32_32x32x16_bf16 v[80:95], v[20:23], v[40:43], v[80:95]
  ds_read_b64_tr_b16 v[28:29], v19 offset:2048
  ds_read_b64_tr_b16 v[30:31], v19 offset:2560
  v_mfma_f32_32x32x16_bf16 v[96:111], v[24:27], v[36:39], v[96:111]
  ds_read_b64_tr_b16 v[32:33], v62 offset:2048
  ds_read_b64_tr_b16 v[34:35], v62 offset:2560
  s_add_u32 m0, s56, 1024
  s_nop 0
  buffer_load_dwordx4 v18, s[12:15], s52 offen lds
  s_add_u32 s52, s52, s53
  v_mfma_f32_32x32x16_bf16 v[112:127], v[24:27], v[40:43], v[112:127]
  s_waitcnt lgkmcnt(0)
  s_waitcnt vmcnt(8)
  v_mfma_f32_32x32x16_bf16 v[64:79], v[28:31], v[44:47], v[64:79]
  ds_read_b128 v[36:39], v16 offset:256
  ds_read_b128 v[40:43], v16 offset:41216
  s_add_u32 m0, s56, 2048
  s_nop 0
  buffer_load_dwordx4 v18, s[12:15], s51 offen lds
  s_add_u32 s51, s51, s53
  v_mfma_f32_32x32x16_bf16 v[80:95], v[28:31], v[48:51], v[80:95]
  ds_read_b64_tr_b16 v[20:21], v19 offset:4096
  ds_read_b64_tr_b16 v[22:23], v19 offset:4608
  v_mfma_f32_32x32x16_bf16 v[96:111], v[32:35], v[44:47], v[96:111]
  ds_read_b64_tr_b16 v[24:25], v62 offset:4096
  ds_read_b64_tr_b16 v[26:27], v62 offset:4608
  s_add_u32 m0, s56, 3072
  s_nop 0
  buffer_load_dwordx4 v18, s[12:15], s52 offen lds
  s_add_u32 s52, s52, s53
  v_mfma_f32_32x32x16_bf16 v[112:127], v[32:35], v[48:51], v[112:127]
  s_waitcnt lgkmcnt(0)
  s_waitcnt vmcnt(8)
  v_mfma_f32_32x32x16_bf16 v[64:79], v[20:23], v[36:39], v[64:79]
  ds_read_b128 v[44:47], v17 offset:256
  ds_read_b128 v[48:51], v17 offset:41216
  s_add_u32 m0, s56, 4096
  s_nop 0
  buffer_load_dwordx4 v18, s[12:15], s51 offen lds
  s_add_u32 s51, s51, s53
  v_mfma_f32_32x32x16_bf16 v[80:95], v[20:23], v[40:43], v[80:95]
  ds_read_b64_tr_b16 v[28:29], v19 offset:6144
  ds_read_b64_tr_b16 v[30:31], v19 offset:6656
  v_mfma_f32_32x32x16_bf16 v[96:111], v[24:27], v[36:39], v[96:111]
  ds_read_b64_tr_b16 v[32:33], v62 offset:6144
  ds_read_b64_tr_b16 v[34:35], v62 offset:6656
  s_add_u32 m0, s56, 5120
  s_nop 0
  buffer_load_dwordx4 v18, s[12:15], s52 offen lds
  s_add_u32 s52, s52, s53
  v_mfma_f32_32x32x16_bf16 v[112:127], v[24:27], v[40:43], v[112:127]
  s_waitcnt lgkmcnt(0)
  s_waitcnt vmcnt(8)
  v_mfma_f32_32x32x16_bf16 v[64:79], v[28:31], v[44:47], v[64:79]
  ds_read_b128 v[36:39], v10 offset:512
  ds_read_b128 v[40:43], v10 offset:41472
  s_add_u32 m0, s56, 6144
  s_nop 0
  buffer_load_dwordx4 v18, s[12:15], s51 offen lds
  s_add_u32 s51, s51, s53
  v_mfma_f32_32x32x16_bf16 v[80:95], v[28:31], v[48:51], v[80:95]
  ds_read_b64_tr_b16 v[20:21], v19 offset:8192
  ds_read_b64_tr_b16 v[22:23], v19 offset:8704
  v_mfma_f32_32x32x16_bf16 v[96:111], v[32:35], v[44:47], v[96:111]
  ds_read_b64_tr_b16 v[24:25], v62 offset:8192
  ds_read_b64_tr_b16 v[26:27], v62 offset:8704
  s_add_u32 m0, s56, 7168
  s_nop 0
  buffer_load_dwordx4 v18, s[12:15], s52 offen lds
  s_add_u32 s52, s52, s53
  v_mfma_f32_32x32x16_bf16 v[112:127], v[32:35], v[48:51], v[112:127]
  s_waitcnt lgkmcnt(0)
  s_waitcnt vmcnt(8)
  v_mfma_f32_32x32x16_bf16 v[64:79], v[20:23], v[36:39], v[64:79]
  ds_read_b128 v[44:47], v11 offset:512
  ds_read_b128 v[48:51], v11 offset:41472
  s_add_u32 m0, s56, 8192
  s_nop 0
  buffer_load_dwordx4 v18, s[12:15], s51 offen lds
  s_add_u32 s51, s51, s53
  v_mfma_f32_32x32x16_bf16 v[80:95], v[20:23], v[40:43], v[80:95]
  ds_read_b64_tr_b16 v[28:29], v19 offset:10240
  ds_read_b64_tr_b16 v[30:31], v19 offset:10752
  v_mfma_f32_32x32x16_bf16 v[96:111], v[24:27], v[36:39], v[96:111]
  ds_read_b64_tr_b16 v[32:33], v62 offset:10240
  ds_read_b64_tr_b16 v[34:35], v62 offset:10752
  s_add_u32 m0, s56, 9216
  s_nop 0
  buffer_load_dwordx4 v18, s[12:15], s52 offen lds
  s_add_u32 s52, s52, s53
  v_mfma_f32_32x32x16_bf16 v[112:127], v[24:27], v[40:43], v[112:127]
  s_waitcnt lgkmcnt(0)
  s_waitcnt vmcnt(8)
  v_mfma_f32_32x32x16_bf16 v[64:79], v[28:31], v[44:47], v[64:79]
  ds_read_b128 v[36:39], v12 offset:512
  ds_read_b128 v[40:43], v12 offset:41472
  s_add_u32 m0, s56, 10240
  s_nop 0
  buffer_load_dwordx4 v18, s[12:15], s51 offen lds
  s_add_u32 s51, s51, s53
  v_mfma_f32_32x32x16_bf16 v[80:95], v[28:31], v[48:51], v[80:95]
  ds_read_b64_tr_b16 v[20:21], v19 offset:0
  ds_read_b64_tr_b16 v[22:23], v19 offset:512
  v_mfma_f32_32x32x16_bf16 v[96:111], v[32:35], v[44:47], v[96:111]
  ds_read_b64_tr_b16 v[24:25], v62 offset:0
  ds_read_b64_tr_b16 v[26:27], v62 offset:512
  s_add_u32 m0, s56, 11264
  s_nop 0
  buffer_load_dwordx4 v18, s[12:15], s52 offen lds
  s_add_u32 s52, s52, s53
  v_mfma_f32_32x32x16_bf16 v[112:127], v[32:35], v[48:51], v[112:127]
  s_waitcnt lgkmcnt(0)
  s_waitcnt vmcnt(8)
  v_mfma_f32_32x32x16_bf16 v[64:79], v[20:23], v[36:39], v[64:79]
  ds_read_b128 v[44:47], v13 offset:512
  ds_read_b128 v[48:51], v13 offset:41472
  s_add_u32 m0, s56, 0
  s_nop 0
  buffer_load_dwordx4 v18, s[12:15], s51 offen lds
  s_add_u32 s51, s51, s53
  v_mfma_f32_32x32x16_bf16 v[80:95], v[20:23], v[40:43], v[80:95]
  ds_read_b64_tr_b16 v[28:29], v19 offset:2048
  ds_read_b64_tr_b16 v[30:31], v19 offset:2560
  v_mfma_f32_32x32x16_bf16 v[96:111], v[24:27], v[36:39], v[96:111]
  ds_read_b64_tr_b16 v[32:33], v62 offset:2048
  ds_read_b64_tr_b16 v[34:35], v62 offset:2560
  s_add_u32 m0, s56, 1024
  s_nop 0
  buffer_load_dwordx4 v18, s[12:15], s52 offen lds
  s_add_u32 s52, s52, s53
  v_mfma_f32_32x32x16_bf16 v[112:127], v[24:27], v[40:43], v[112:127]
  s_waitcnt lgkmcnt(0)
  s_waitcnt vmcnt(8)
  v_mfma_f32_32x32x16_bf16 v[64:79], v[28:31], v[44:47], v[64:79]
  ds_read_b128 v[36:39], v14 offset:512
  ds_read_b128 v[40:43], v14 offset:41472
  s_add_u32 m0, s56, 2048
  s_nop 0
  buffer_load_dwordx4 v18, s[12:15], s51 offen lds
  s_add_u32 s51, s51, s53
  v_mfma_f32_32x32x16_bf16 v[80:95], v[28:31], v[48:51], v[80:95]
  ds_read_b64_tr_b16 v[20:21], v19 offset:4096
  ds_read_b64_tr_b16 v[22:23], v19 offset:4608
  v_mfma_f32_32x32x16_bf16 v[96:111], v[32:35], v[44:47], v[96:111]
  ds_read_b64_tr_b16 v[24:25], v62 offset:4096
  ds_read_b64_tr_b16 v[26:27], v62 offset:4608
  s_add_u32 m0, s56, 3072
  s_nop 0
  buffer_load_dwordx4 v18, s[12:15], s52 offen lds
  s_add_u32 s52, s52, s53
  v_mfma_f32_32x32x16_bf16 v[112:127], v[32:35], v[48:51], v[112:127]
  s_waitcnt lgkmcnt(0)
  s_waitcnt vmcnt(8)
  v_mfma_f32_32x32x16_bf16 v[64:79], v[20:23], v[36:39], v[64:79]
  ds_read_b128 v[44:47], v15 offset:512
  ds_read_b128 v[48:51], v15 offset:41472
  s_add_u32 m0, s56, 4096
  s_nop 0
  buffer_load_dwordx4 v18, s[12:15], s51 offen lds
  s_add_u32 s51, s51, s53
  v_mfma_f32_32x32x16_bf16 v[80:95], v[20:23], v[40:43], v[80:95]
  ds_read_b64_tr_b16 v[28:29], v19 offset:6144
  ds_read_b64_tr_b16 v[30:31], v19 offset:6656
  v_mfma_f32_32x32x16_bf16 v[96:111], v[24:27], v[36:39], v[96:111]
  ds_read_b64_tr_b16 v[32:33], v62 offset:6144
  ds_read_b64_tr_b16 v[34:35], v62 offset:6656
  s_add_u32 m0, s56, 5120
  s_nop 0
  buffer_load_dwordx4 v18, s[12:15], s52 offen lds
  s_add_u32 s52, s52, s53
  v_mfma_f32_32x32x16_bf16 v[112:127], v[24:27], v[40:43], v[112:127]
  s_waitcnt lgkmcnt(0)
  s_waitcnt vmcnt(8)
  v_mfma_f32_32x32x16_bf16 v[64:79], v[28:31], v[44:47], v[64:79]
  ds_read_b128 v[36:39], v16 offset:512
  ds_read_b128 v[40:43], v16 offset:41472
  s_add_u32 m0, s56, 6144
  s_nop 0
  buffer_load_dwordx4 v18, s[12:15], s51 offen lds
  s_add_u32 s51, s51, s53
  v_mfma_f32_32x32x16_bf16 v[80:95], v[28:31], v[48:51], v[80:95]
  ds_read_b64_tr_b16 v[20:21], v19 offset:8192
  ds_read_b64_tr_b16 v[22:23], v19 offset:8704
  v_mfma_f32_32x32x16_bf16 v[96:111], v[32:35], v[44:47], v[96:111]
  ds_read_b64_tr_b16 v[24:25], v62 offset:8192
  ds_read_b64_tr_b16 v[26:27], v62 offset:8704
  s_add_u32 m0, s56, 7168
  s_nop 0
  buffer_load_dwordx4 v18, s[12:15], s52 offen lds
  s_add_u32 s52, s52, s53
  v_mfma_f32_32x32x16_bf16 v[112:127], v[32:35], v[48:51], v[112:127]
  s_waitcnt lgkmcnt(0)
  s_waitcnt vmcnt(8)
  v_mfma_f32_32x32x16_bf16 v[64:79], v[20:23], v[36:39], v[64:79]
  ds_read_b128 v[44:47], v17 offset:512
  ds_read_b128 v[48:51], v17 offset:41472
  s_add_u32 m0, s56, 8192
  s_nop 0
  buffer_load_dwordx4 v18, s[12:15], s51 offen lds
  s_add_u32 s51, s51, s53
  v_mfma_f32_32x32x16_bf16 v[80:95], v[20:23], v[40:43], v[80:95]
  ds_read_b64_tr_b16 v[28:29], v19 offset:10240
  ds_read_b64_tr_b16 v[30:31], v19 offset:10752
  v_mfma_f32_32x32x16_bf16 v[96:111], v[24:27], v[36:39], v[96:111]
  ds_read_b64_tr_b16 v[32:33], v62 offset:10240
  ds_read_b64_tr_b16 v[34:35], v62 offset:10752
  s_add_u32 m0, s56, 9216
  s_nop 0
  buffer_load_dwordx4 v18, s[12:15], s52 offen lds
  s_add_u32 s52, s52, s53
  v_mfma_f32_32x32x16_bf16 v[112:127], v[24:27], v[40:43], v[112:127]
  s_waitcnt lgkmcnt(0)
  s_waitcnt vmcnt(8)
  v_mfma_f32_32x32x16_bf16 v[64:79], v[28:31], v[44:47], v[64:79]
  ds_read_b128 v[36:39], v10 offset:768
  ds_read_b128 v[40:43], v10 offset:41728
  s_add_u32 m0, s56, 10240
  s_nop 0
  buffer_load_dwordx4 v18, s[12:15], s51 offen lds
  s_add_u32 s51, s51, s53
  v_mfma_f32_32x32x16_bf16 v[80:95], v[28:31], v[48:51], v[80:95]
  ds_read_b64_tr_b16 v[20:21], v19 offset:0
  ds_read_b64_tr_b16 v[22:23], v19 offset:512
  v_mfma_f32_32x32x16_bf16 v[96:111], v[32:35], v[44:47], v[96:111]
  ds_read_b64_tr_b16 v[24:25], v62 offset:0
  ds_read_b64_tr_b16 v[26:27], v62 offset:512
  s_add_u32 m0, s56, 11264
  s_nop 0
  buffer_load_dwordx4 v18, s[12:15], s52 offen lds
  s_add_u32 s52, s52, s53
  v_mfma_f32_32x32x16_bf16 v[112:127], v[32:35], v[48:51], v[112:127]
  s_waitcnt lgkmcnt(0)
  s_waitcnt vmcnt(8)
  v_mfma_f32_32x32x16_bf16 v[64:79], v[20:23], v[36:39], v[64:79]
  ds_read_b128 v[44:47], v11 offset:768
  ds_read_b128 v[48:51], v11 offset:41728
  s_add_u32 m0, s56, 0
  s_nop 0
  buffer_load_dwordx4 v18, s[12:15], s51 offen lds
  s_add_u32 s51, s51, s53
  v_mfma_f32_32x32x16_bf16 v[80:95], v[20:23], v[40:43], v[80:95]
  ds_read_b64_tr_b16 v[28:29], v19 offset:2048
  ds_read_b64_tr_b16 v[30:31], v19 offset:2560
  v_mfma_f32_32x32x16_bf16 v[96:111], v[24:27], v[36:39], v[96:111]
  ds_read_b64_tr_b16 v[32:33], v62 offset:2048
  ds_read_b64_tr_b16 v[34:35], v62 offset:2560
  s_add_u32 m0, s56, 1024
  s_nop 0
  buffer_load_dwordx4 v18, s[12:15], s52 offen lds
  s_add_u32 s52, s52, s53
  v_mfma_f32_32x32x16_bf16 v[112:127], v[24:27], v[40:43], v[112:127]
  s_waitcnt lgkmcnt(0)
  s_waitcnt vmcnt(8)
  v_mfma_f32_32x32x16_bf16 v[64:79], v[28:31], v[44:47], v[64:79]
  ds_read_b128 v[36:39], v12 offset:768
  ds_read_b128 v[40:43], v12 offset:41728
  s_add_u32 m0, s56, 2048
  s_nop 0
  buffer_load_dwordx4 v18, s[12:15], s51 offen lds
  s_add_u32 s51, s51, s53
  v_mfma_f32_32x32x16_bf16 v[80:95], v[28:31], v[48:51], v[80:95]
  ds_read_b64_tr_b16 v[20:21], v19 offset:4096
  ds_read_b64_tr_b16 v[22:23], v19 offset:4608
  v_mfma_f32_32x32x16_bf16 v[96:111], v[32:35], v[44:47], v[96:111]
  ds_read_b64_tr_b16 v[24:25], v62 offset:4096
  ds_read_b64_tr_b16 v[26:27], v62 offset:4608
  s_add_u32 m0, s56, 3072
  s_nop 0
  buffer_load_dwordx4 v18, s[12:15], s52 offen lds
  s_add_u32 s52, s52, s53
  v_mfma_f32_32x32x16_bf16 v[112:127], v[32:35], v[48:51], v[112:127]
  s_waitcnt lgkmcnt(0)
  s_waitcnt vmcnt(8)
  v_mfma_f32_32x32x16_bf16 v[64:79], v[20:23], v[36:39], v[64:79]
  ds_read_b128 v[44:47], v13 offset:768
  ds_read_b128 v[48:51], v13 offset:41728
  s_add_u32 m0, s56, 4096
  s_nop 0
  buffer_load_dwordx4 v18, s[12:15], s51 offen lds
  s_add_u32 s51, s51, s53
  v_mfma_f32_32x32x16_bf16 v[80:95], v[20:23], v[40:43], v[80:95]
  ds_read_b64_tr_b16 v[28:29], v19 offset:6144
  ds_read_b64_tr_b16 v[30:31], v19 offset:6656
  v_mfma_f32_32x32x16_bf16 v[96:111], v[24:27], v[36:39], v[96:111]
  ds_read_b64_tr_b16 v[32:33], v62 offset:6144
  ds_read_b64_tr_b16 v[34:35], v62 offset:6656
  s_add_u32 m0, s56, 5120
  s_nop 0
  buffer_load_dwordx4 v18, s[12:15], s52 offen lds
  s_add_u32 s52, s52, s53
  v_mfma_f32_32x32x16_bf16 v[112:127], v[24:27], v[40:43], v[112:127]
  s_waitcnt lgkmcnt(0)
  s_waitcnt vmcnt(8)
  v_mfma_f32_32x32x16_bf16 v[64:79], v[28:31], v[44:47], v[64:79]
  ds_read_b128 v[36:39], v14 offset:768
  ds_read_b128 v[40:43], v14 offset:41728
  s_add_u32 m0, s56, 6144
  s_nop 0
  buffer_load_dwordx4 v18, s[12:15], s51 offen lds
  s_add_u32 s51, s51, s53
  v_mfma_f32_32x32x16_bf16 v[80:95], v[28:31], v[48:51], v[80:95]
  ds_read_b64_tr_b16 v[20:21], v19 offset:8192
  ds_read_b64_tr_b16 v[22:23], v19 offset:8704
  v_mfma_f32_32x32x16_bf16 v[96:111], v[32:35], v[44:47], v[96:111]
  ds_read_b64_tr_b16 v[24:25], v62 offset:8192
  ds_read_b64_tr_b16 v[26:27], v62 offset:8704
  s_add_u32 m0, s56, 7168
  s_nop 0
  buffer_load_dwordx4 v18, s[12:15], s52 offen lds
  s_add_u32 s52, s52, s53
  v_mfma_f32_32x32x16_bf16 v[112:127], v[32:35], v[48:51], v[112:127]
  s_waitcnt lgkmcnt(0)
  s_waitcnt vmcnt(8)
  v_mfma_f32_32x32x16_bf16 v[64:79], v[20:23], v[36:39], v[64:79]
  ds_read_b128 v[44:47], v15 offset:768
  ds_read_b128 v[48:51], v15 offset:41728
  s_add_u32 m0, s56, 8192
  s_nop 0
  buffer_load_dwordx4 v18, s[12:15], s51 offen lds
  s_add_u32 s51, s51, s53
  v_mfma_f32_32x32x16_bf16 v[80:95], v[20:23], v[40:43], v[80:95]
  ds_read_b64_tr_b16 v[28:29], v19 offset:10240
  ds_read_b64_tr_b16 v[30:31], v19 offset:10752
  v_mfma_f32_32x32x16_bf16 v[96:111], v[24:27], v[36:39], v[96:111]
  ds_read_b64_tr_b16 v[32:33], v62 offset:10240
  ds_read_b64_tr_b16 v[34:35], v62 offset:10752
  s_add_u32 m0, s56, 9216
  s_nop 0
  buffer_load_dwordx4 v18, s[12:15], s52 offen lds
  s_add_u32 s52, s52, s53
  v_mfma_f32_32x32x16_bf16 v[112:127], v[24:27], v[40:43], v[112:127]
  s_waitcnt lgkmcnt(0)
  s_waitcnt vmcnt(8)
  v_mfma_f32_32x32x16_bf16 v[64:79], v[28:31], v[44:47], v[64:79]
  ds_read_b128 v[36:39], v16 offset:768
  ds_read_b128 v[40:43], v16 offset:41728
  s_add_u32 m0, s56, 10240
  s_nop 0
  buffer_load_dwordx4 v18, s[12:15], s51 offen lds
  s_add_u32 s51, s51, s53
  v_mfma_f32_32x32x16_bf16 v[80:95], v[28:31], v[48:51], v[80:95]
  ds_read_b64_tr_b16 v[20:21], v19 offset:0
  ds_read_b64_tr_b16 v[22:23], v19 offset:512
  v_mfma_f32_32x32x16_bf16 v[96:111], v[32:35], v[44:47], v[96:111]
  ds_read_b64_tr_b16 v[24:25], v62 offset:0
  ds_read_b64_tr_b16 v[26:27], v62 offset:512
  s_add_u32 m0, s56, 11264
  s_nop 0
  buffer_load_dwordx4 v18, s[12:15], s52 offen lds
  s_add_u32 s52, s52, s53
  v_mfma_f32_32x32x16_bf16 v[112:127], v[32:35], v[48:51], v[112:127]
  s_waitcnt lgkmcnt(0)
  s_waitcnt vmcnt(8)
  v_mfma_f32_32x32x16_bf16 v[64:79], v[20:23], v[36:39], v[64:79]
  ds_read_b128 v[44:47], v17 offset:768
  ds_read_b128 v[48:51], v17 offset:41728
  s_add_u32 m0, s56, 0
  s_nop 0
  buffer_load_dwordx4 v18, s[12:15], s51 offen lds
  s_add_u32 s51, s51, s53
  v_mfma_f32_32x32x16_bf16 v[80:95], v[20:23], v[40:43], v[80:95]
  ds_read_b64_tr_b16 v[28:29], v19 offset:2048
  ds_read_b64_tr_b16 v[30:31], v19 offset:2560
  v_mfma_f32_32x32x16_bf16 v[96:111], v[24:27], v[36:39], v[96:111]
  ds_read_b64_tr_b16 v[32:33], v62 offset:2048
  ds_read_b64_tr_b16 v[34:35], v62 offset:2560
  s_add_u32 m0, s56, 1024
  s_nop 0
  buffer_load_dwordx4 v18, s[12:15], s52 offen lds
  s_add_u32 s52, s52, s53
  v_mfma_f32_32x32x16_bf16 v[112:127], v[24:27], v[40:43], v[112:127]
  s_waitcnt lgkmcnt(0)
  s_waitcnt vmcnt(8)
  v_mfma_f32_32x32x16_bf16 v[64:79], v[28:31], v[44:47], v[64:79]
  ds_read_b128 v[36:39], v10 offset:1024
  ds_read_b128 v[40:43], v10 offset:41984
  s_add_u32 m0, s56, 2048
  s_nop 0
  buffer_load_dwordx4 v18, s[12:15], s51 offen lds
  s_add_u32 s51, s51, s53
  v_mfma_f32_32x32x16_bf16 v[80:95], v[28:31], v[48:51], v[80:95]
  ds_read_b64_tr_b16 v[20:21], v19 offset:4096
  ds_read_b64_tr_b16 v[22:23], v19 offset:4608
  v_mfma_f32_32x32x16_bf16 v[96:111], v[32:35], v[44:47], v[96:111]
  ds_read_b64_tr_b16 v[24:25], v62 offset:4096
  ds_read_b64_tr_b16 v[26:27], v62 offset:4608
  s_add_u32 m0, s56, 3072
  s_nop 0
  buffer_load_dwordx4 v18, s[12:15], s52 offen lds
  s_add_u32 s52, s52, s53
  v_mfma_f32_32x32x16_bf16 v[112:127], v[32:35], v[48:51], v[112:127]
  s_waitcnt lgkmcnt(0)
  s_waitcnt vmcnt(8)
  v_mfma_f32_32x32x16_bf16 v[64:79], v[20:23], v[36:39], v[64:79]
  ds_read_b128 v[44:47], v11 offset:1024
  ds_read_b128 v[48:51], v11 offset:41984
  s_add_u32 m0, s56, 4096
  s_nop 0
  buffer_load_dwordx4 v18, s[12:15], s51 offen lds
  s_add_u32 s51, s51, s53
  v_mfma_f32_32x32x16_bf16 v[80:95], v[20:23], v[40:43], v[80:95]
  ds_read_b64_tr_b16 v[28:29], v19 offset:6144
  ds_read_b64_tr_b16 v[30:31], v19 offset:6656
  v_mfma_f32_32x32x16_bf16 v[96:111], v[24:27], v[36:39], v[96:111]
  ds_read_b64_tr_b16 v[32:33], v62 offset:6144
  ds_read_b64_tr_b16 v[34:35], v62 offset:6656
  s_add_u32 m0, s56, 5120
  s_nop 0
  buffer_load_dwordx4 v18, s[12:15], s52 offen lds
  s_add_u32 s52, s52, s53
  v_mfma_f32_32x32x16_bf16 v[112:127], v[24:27], v[40:43], v[112:127]
  s_waitcnt lgkmcnt(0)
  s_waitcnt vmcnt(8)
  v_mfma_f32_32x32x16_bf16 v[64:79], v[28:31], v[44:47], v[64:79]
  ds_read_b128 v[36:39], v12 offset:1024
  ds_read_b128 v[40:43], v12 offset:41984
  s_add_u32 m0, s56, 6144
  s_nop 0
  buffer_load_dwordx4 v18, s[12:15], s51 offen lds
  s_add_u32 s51, s51, s53
  v_mfma_f32_32x32x16_bf16 v[80:95], v[28:31], v[48:51], v[80:95]
  ds_read_b64_tr_b16 v[20:21], v19 offset:8192
  ds_read_b64_tr_b16 v[22:23], v19 offset:8704
  v_mfma_f32_32x32x16_bf16 v[96:111], v[32:35], v[44:47], v[96:111]
  ds_read_b64_tr_b16 v[24:25], v62 offset:8192
  ds_read_b64_tr_b16 v[26:27], v62 offset:8704
  s_add_u32 m0, s56, 7168
  s_nop 0
  buffer_load_dwordx4 v18, s[12:15], s52 offen lds
  s_add_u32 s52, s52, s53
  v_mfma_f32_32x32x16_bf16 v[112:127], v[32:35], v[48:51], v[112:127]
  s_waitcnt lgkmcnt(0)
  s_waitcnt vmcnt(8)
  v_mfma_f32_32x32x16_bf16 v[64:79], v[20:23], v[36:39], v[64:79]
  ds_read_b128 v[44:47], v13 offset:1024
  ds_read_b128 v[48:51], v13 offset:41984
  v_mfma_f32_32x32x16_bf16 v[80:95], v[20:23], v[40:43], v[80:95]
  ds_read_b64_tr_b16 v[28:29], v19 offset:10240
  ds_read_b64_tr_b16 v[30:31], v19 offset:10752
  v_mfma_f32_32x32x16_bf16 v[96:111], v[24:27], v[36:39], v[96:111]
  ds_read_b64_tr_b16 v[32:33], v62 offset:10240
  ds_read_b64_tr_b16 v[34:35], v62 offset:10752
  v_mfma_f32_32x32x16_bf16 v[112:127], v[24:27], v[40:43], v[112:127]
  s_waitcnt lgkmcnt(0)
  s_waitcnt vmcnt(6)
  v_mfma_f32_32x32x16_bf16 v[64:79], v[28:31], v[44:47], v[64:79]
  ds_read_b128 v[36:39], v14 offset:1024
  ds_read_b128 v[40:43], v14 offset:41984
  v_mfma_f32_32x32x16_bf16 v[80:95], v[28:31], v[48:51], v[80:95]
  ds_read_b64_tr_b16 v[20:21], v19 offset:0
  ds_read_b64_tr_b16 v[22:23], v19 offset:512
  v_mfma_f32_32x32x16_bf16 v[96:111], v[32:35], v[44:47], v[96:111]
  ds_read_b64_tr_b16 v[24:25], v62 offset:0
  ds_read_b64_tr_b16 v[26:27], v62 offset:512
  v_mfma_f32_32x32x16_bf16 v[112:127], v[32:35], v[48:51], v[112:127]
  s_waitcnt lgkmcnt(0)
  s_waitcnt vmcnt(4)
  v_mfma_f32_32x32x16_bf16 v[64:79], v[20:23], v[36:39], v[64:79]
  ds_read_b128 v[44:47], v15 offset:1024
  ds_read_b128 v[48:51], v15 offset:41984
  v_mfma_f32_32x32x16_bf16 v[80:95], v[20:23], v[40:43], v[80:95]
  ds_read_b64_tr_b16 v[28:29], v19 offset:2048
  ds_read_b64_tr_b16 v[30:31], v19 offset:2560
  v_mfma_f32_32x32x16_bf16 v[96:111], v[24:27], v[36:39], v[96:111]
  ds_read_b64_tr_b16 v[32:33], v62 offset:2048
  ds_read_b64_tr_b16 v[34:35], v62 offset:2560
  v_mfma_f32_32x32x16_bf16 v[112:127], v[24:27], v[40:43], v[112:127]
  s_waitcnt lgkmcnt(0)
  s_waitcnt vmcnt(2)
  v_mfma_f32_32x32x16_bf16 v[64:79], v[28:31], v[44:47], v[64:79]
  ds_read_b128 v[36:39], v16 offset:1024
  ds_read_b128 v[40:43], v16 offset:41984
  v_mfma_f32_32x32x16_bf16 v[80:95], v[28:31], v[48:51], v[80:95]
  ds_read_b64_tr_b16 v[20:21], v19 offset:4096
  ds_read_b64_tr_b16 v[22:23], v19 offset:4608
  v_mfma_f32_32x32x16_bf16 v[96:111], v[32:35], v[44:47], v[96:111]
  ds_read_b64_tr_b16 v[24:25], v62 offset:4096
  ds_read_b64_tr_b16 v[26:27], v62 offset:4608
  v_mfma_f32_32x32x16_bf16 v[112:127], v[32:35], v[48:51], v[112:127]
  s_waitcnt lgkmcnt(0)
  s_waitcnt vmcnt(0)
  v_mfma_f32_32x32x16_bf16 v[64:79], v[20:23], v[36:39], v[64:79]
  ds_read_b128 v[44:47], v17 offset:1024
  ds_read_b128 v[48:51], v17 offset:41984
  v_mfma_f32_32x32x16_bf16 v[80:95], v[20:23], v[40:43], v[80:95]
  ds_read_b64_tr_b16 v[28:29], v19 offset:6144
  ds_read_b64_tr_b16 v[30:31], v19 offset:6656
  v_mfma_f32_32x32x16_bf16 v[96:111], v[24:27], v[36:39], v[96:111]
  ds_read_b64_tr_b16 v[32:33], v62 offset:6144
  ds_read_b64_tr_b16 v[34:35], v62 offset:6656
  v_mfma_f32_32x32x16_bf16 v[112:127], v[24:27], v[40:43], v[112:127]
  s_waitcnt lgkmcnt(0)
  v_mfma_f32_32x32x16_bf16 v[64:79], v[28:31], v[44:47], v[64:79]
  v_mfma_f32_32x32x16_bf16 v[80:95], v[28:31], v[48:51], v[80:95]
  v_mfma_f32_32x32x16_bf16 v[96:111], v[32:35], v[44:47], v[96:111]
  v_mfma_f32_32x32x16_bf16 v[112:127], v[32:35], v[48:51], v[112:127]
  s_nop 15
  s_lshr_b32 s60, s2, 3
  s_and_b32 s61, s2, 1
  s_sub_u32 s62, s46, 4
  s_mul_i32 s63, s60, 54
  s_mul_i32 s68, s62, 14
  s_add_u32 s63, s63, s68
  s_mul_i32 s68, s61, 640
  s_mov_b32 s16, s36
  s_and_b32 s17, s37, 0xffff
  s_mov_b32 s18, 0x21c000
  s_mov_b32 s19, 0x00020000
  v_lshrrev_b32 v60, 3, v1
  v_and_b32 v61, 7, v1
  v_min_u32 v61, 5, v61
  v_add_u32 v60, s63, v60
  v_mul_u32_u24 v60, 1280, v60
  v_lshl_add_u32 v60, v61, 7, v60
  buffer_load_dword v159, v60, s[16:19], s68 offen
  s_add_u32 s63, s63, 8
  s_mov_b32 s16, s36
  s_and_b32 s17, s37, 0xffff
  s_mov_b32 s18, 0x21c000
  s_mov_b32 s19, 0x00020000
  v_lshrrev_b32 v60, 3, v1
  v_and_b32 v61, 7, v1
  v_min_u32 v61, 5, v61
  v_add_u32 v60, s63, v60
  v_mul_u32_u24 v60, 1280, v60
  v_lshl_add_u32 v60, v61, 7, v60
  buffer_load_dword v159, v60, s[16:19], s68 offen
  s_mul_i32 s63, s60, 20
  s_mul_i32 s62, s62, 5
  s_add_u32 s63, s63, s62
  s_mov_b32 s16, s28
  s_and_b32 s17, s29, 0xffff
  s_mov_b32 s18, 0xc8000
  s_mov_b32 s19, 0x00020000
  v_lshrrev_b32 v60, 3, v1
  v_and_b32 v61, 7, v1
  v_min_u32 v61, 5, v61
  v_add_u32 v60, s63, v60
  v_mul_u32_u24 v60, 1280, v60
  v_lshl_add_u32 v60, v61, 7, v60
  buffer_load_dword v159, v60, s[16:19], s68 offen
  v_mov_b32 v52, 0xc0135761
  v_mov_b32 v54, 0xbdd2d3e8
  v_mov_b32 v56, 1.0
  v_mov_b32 v53, 0xc0135761
  v_mov_b32 v55, 0xbdd2d3e8
  v_mov_b32 v57, 1.0
  s_mul_i32 s60, s47, 221184
  s_lshl_b32 s61, s59, 11
  s_add_u32 s100, s60, s61
  s_add_u32 s100, s100, 524288
  v_lshlrev_b32 v58, 4, v1
  v_pk_mul_f32 v[36:37], v[64:65], v[64:65]
  v_pk_mul_f32 v[38:39], v[66:67], v[66:67]
  v_pk_mul_f32 v[40:41], v[68:69], v[68:69]
  v_pk_mul_f32 v[42:43], v[70:71], v[70:71]
  v_pk_fma_f32 v[36:37], v[36:37], v[54:55], v[52:53]
  v_pk_fma_f32 v[38:39], v[38:39], v[54:55], v[52:53]
  v_pk_fma_f32 v[40:41], v[40:41], v[54:55], v[52:53]
  v_pk_fma_f32 v[42:43], v[42:43], v[54:55], v[52:53]
  v_pk_mul_f32 v[36:37], v[36:37], v[64:65]
  v_pk_mul_f32 v[38:39], v[38:39], v[66:67]
  v_pk_mul_f32 v[40:41], v[40:41], v[68:69]
  v_pk_mul_f32 v[42:43], v[42:43], v[70:71]
  v_exp_f32 v36, v36
  v_exp_f32 v37, v37
  v_exp_f32 v38, v38
  v_exp_f32 v39, v39
  v_exp_f32 v40, v40
  v_exp_f32 v41, v41
  v_exp_f32 v42, v42
  v_exp_f32 v43, v43
  v_pk_add_f32 v[36:37], v[36:37], v[56:57]
  v_pk_add_f32 v[38:39], v[38:39], v[56:57]
  v_pk_add_f32 v[40:41], v[40:41], v[56:57]
  v_pk_add_f32 v[42:43], v[42:43], v[56:57]
  v_rcp_f32 v36, v36
  v_rcp_f32 v37, v37
  v_rcp_f32 v38, v38
  v_rcp_f32 v39, v39
  v_rcp_f32 v40, v40
  v_rcp_f32 v41, v41
  v_rcp_f32 v42, v42
  v_rcp_f32 v43, v43
  v_pk_mul_f32 v[64:65], v[64:65], v[36:37]
  v_pk_mul_f32 v[66:67], v[66:67], v[38:39]
  v_pk_mul_f32 v[68:69], v[68:69], v[40:41]
  v_pk_mul_f32 v[70:71], v[70:71], v[42:43]
  v_cvt_pk_bf16_f32 v64, v64, v65
  v_cvt_pk_bf16_f32 v65, v66, v67
  v_cvt_pk_bf16_f32 v66, v68, v69
  v_cvt_pk_bf16_f32 v67, v70, v71
  v_pk_mul_f32 v[36:37], v[72:73], v[72:73]
  v_pk_mul_f32 v[38:39], v[74:75], v[74:75]
  v_pk_mul_f32 v[40:41], v[76:77], v[76:77]
  v_pk_mul_f32 v[42:43], v[78:79], v[78:79]
  v_pk_fma_f32 v[36:37], v[36:37], v[54:55], v[52:53]
  v_pk_fma_f32 v[38:39], v[38:39], v[54:55], v[52:53]
  v_pk_fma_f32 v[40:41], v[40:41], v[54:55], v[52:53]
  v_pk_fma_f32 v[42:43], v[42:43], v[54:55], v[52:53]
  v_pk_mul_f32 v[36:37], v[36:37], v[72:73]
  v_pk_mul_f32 v[38:39], v[38:39], v[74:75]
  v_pk_mul_f32 v[40:41], v[40:41], v[76:77]
  v_pk_mul_f32 v[42:43], v[42:43], v[78:79]
  v_exp_f32 v36, v36
  v_exp_f32 v37, v37
  v_exp_f32 v38, v38
  v_exp_f32 v39, v39
  v_exp_f32 v40, v40
  v_exp_f32 v41, v41
  v_exp_f32 v42, v42
  v_exp_f32 v43, v43
  v_pk_add_f32 v[36:37], v[36:37], v[56:57]
  v_pk_add_f32 v[38:39], v[38:39], v[56:57]
  v_pk_add_f32 v[40:41], v[40:41], v[56:57]
  v_pk_add_f32 v[42:43], v[42:43], v[56:57]
  v_rcp_f32 v36, v36
  v_rcp_f32 v37, v37
  v_rcp_f32 v38, v38
  v_rcp_f32 v39, v39
  v_rcp_f32 v40, v40
  v_rcp_f32 v41, v41
  v_rcp_f32 v42, v42
  v_rcp_f32 v43, v43
  v_pk_mul_f32 v[72:73], v[72:73], v[36:37]
  v_pk_mul_f32 v[74:75], v[74:75], v[38:39]
  v_pk_mul_f32 v[76:77], v[76:77], v[40:41]
  v_pk_mul_f32 v[78:79], v[78:79], v[42:43]
  v_cvt_pk_bf16_f32 v68, v72, v73
  v_cvt_pk_bf16_f32 v69, v74, v75
  v_cvt_pk_bf16_f32 v70, v76, v77
  v_cvt_pk_bf16_f32 v71, v78, v79
  s_add_u32 s61, s100, 0
  buffer_store_dwordx4 v[64:67], v58, s[8:11], s61 offen sc1
  s_add_u32 s61, s100, 1024
  buffer_store_dwordx4 v[68:71], v58, s[8:11], s61 offen sc1
  v_pk_mul_f32 v[36:37], v[80:81], v[80:81]
  v_pk_mul_f32 v[38:39], v[82:83], v[82:83]
  v_pk_mul_f32 v[40:41], v[84:85], v[84:85]
  v_pk_mul_f32 v[42:43], v[86:87], v[86:87]
  v_pk_fma_f32 v[36:37], v[36:37], v[54:55], v[52:53]
  v_pk_fma_f32 v[38:39], v[38:39], v[54:55], v[52:53]
  v_pk_fma_f32 v[40:41], v[40:41], v[54:55], v[52:53]
  v_pk_fma_f32 v[42:43], v[42:43], v[54:55], v[52:53]
  v_pk_mul_f32 v[36:37], v[36:37], v[80:81]
  v_pk_mul_f32 v[38:39], v[38:39], v[82:83]
  v_pk_mul_f32 v[40:41], v[40:41], v[84:85]
  v_pk_mul_f32 v[42:43], v[42:43], v[86:87]
  v_exp_f32 v36, v36
  v_exp_f32 v37, v37
  v_exp_f32 v38, v38
  v_exp_f32 v39, v39
  v_exp_f32 v40, v40
  v_exp_f32 v41, v41
  v_exp_f32 v42, v42
  v_exp_f32 v43, v43
  v_pk_add_f32 v[36:37], v[36:37], v[56:57]
  v_pk_add_f32 v[38:39], v[38:39], v[56:57]
  v_pk_add_f32 v[40:41], v[40:41], v[56:57]
  v_pk_add_f32 v[42:43], v[42:43], v[56:57]
  v_rcp_f32 v36, v36
  v_rcp_f32 v37, v37
  v_rcp_f32 v38, v38
  v_rcp_f32 v39, v39
  v_rcp_f32 v40, v40
  v_rcp_f32 v41, v41
  v_rcp_f32 v42, v42
  v_rcp_f32 v43, v43
  v_pk_mul_f32 v[80:81], v[80:81], v[36:37]
  v_pk_mul_f32 v[82:83], v[82:83], v[38:39]
  v_pk_mul_f32 v[84:85], v[84:85], v[40:41]
  v_pk_mul_f32 v[86:87], v[86:87], v[42:43]
  v_cvt_pk_bf16_f32 v80, v80, v81
  v_cvt_pk_bf16_f32 v81, v82, v83
  v_cvt_pk_bf16_f32 v82, v84, v85
  v_cvt_pk_bf16_f32 v83, v86, v87
  v_pk_mul_f32 v[36:37], v[88:89], v[88:89]
  v_pk_mul_f32 v[38:39], v[90:91], v[90:91]
  v_pk_mul_f32 v[40:41], v[92:93], v[92:93]
  v_pk_mul_f32 v[42:43], v[94:95], v[94:95]
  v_pk_fma_f32 v[36:37], v[36:37], v[54:55], v[52:53]
  v_pk_fma_f32 v[38:39], v[38:39], v[54:55], v[52:53]
  v_pk_fma_f32 v[40:41], v[40:41], v[54:55], v[52:53]
  v_pk_fma_f32 v[42:43], v[42:43], v[54:55], v[52:53]
  v_pk_mul_f32 v[36:37], v[36:37], v[88:89]
  v_pk_mul_f32 v[38:39], v[38:39], v[90:91]
  v_pk_mul_f32 v[40:41], v[40:41], v[92:93]
  v_pk_mul_f32 v[42:43], v[42:43], v[94:95]
  v_exp_f32 v36, v36
  v_exp_f32 v37, v37
  v_exp_f32 v38, v38
  v_exp_f32 v39, v39
  v_exp_f32 v40, v40
  v_exp_f32 v41, v41
  v_exp_f32 v42, v42
  v_exp_f32 v43, v43
  v_pk_add_f32 v[36:37], v[36:37], v[56:57]
  v_pk_add_f32 v[38:39], v[38:39], v[56:57]
  v_pk_add_f32 v[40:41], v[40:41], v[56:57]
  v_pk_add_f32 v[42:43], v[42:43], v[56:57]
  v_rcp_f32 v36, v36
  v_rcp_f32 v37, v37
  v_rcp_f32 v38, v38
  v_rcp_f32 v39, v39
  v_rcp_f32 v40, v40
  v_rcp_f32 v41, v41
  v_rcp_f32 v42, v42
  v_rcp_f32 v43, v43
  v_pk_mul_f32 v[88:89], v[88:89], v[36:37]
  v_pk_mul_f32 v[90:91], v[90:91], v[38:39]
  v_pk_mul_f32 v[92:93], v[92:93], v[40:41]
  v_pk_mul_f32 v[94:95], v[94:95], v[42:43]
  v_cvt_pk_bf16_f32 v84, v88, v89
  v_cvt_pk_bf16_f32 v85, v90, v91
  v_cvt_pk_bf16_f32 v86, v92, v93
  v_cvt_pk_bf16_f32 v87, v94, v95
  s_add_u32 s61, s100, 110592
  buffer_store_dwordx4 v[80:83], v58, s[8:11], s61 offen sc1
  s_add_u32 s61, s100, 111616
  buffer_store_dwordx4 v[84:87], v58, s[8:11], s61 offen sc1
  v_pk_mul_f32 v[36:37], v[96:97], v[96:97]
  v_pk_mul_f32 v[38:39], v[98:99], v[98:99]
  v_pk_mul_f32 v[40:41], v[100:101], v[100:101]
  v_pk_mul_f32 v[42:43], v[102:103], v[102:103]
  v_pk_fma_f32 v[36:37], v[36:37], v[54:55], v[52:53]
  v_pk_fma_f32 v[38:39], v[38:39], v[54:55], v[52:53]
  v_pk_fma_f32 v[40:41], v[40:41], v[54:55], v[52:53]
  v_pk_fma_f32 v[42:43], v[42:43], v[54:55], v[52:53]
  v_pk_mul_f32 v[36:37], v[36:37], v[96:97]
  v_pk_mul_f32 v[38:39], v[38:39], v[98:99]
  v_pk_mul_f32 v[40:41], v[40:41], v[100:101]
  v_pk_mul_f32 v[42:43], v[42:43], v[102:103]
  v_exp_f32 v36, v36
  v_exp_f32 v37, v37
  v_exp_f32 v38, v38
  v_exp_f32 v39, v39
  v_exp_f32 v40, v40
  v_exp_f32 v41, v41
  v_exp_f32 v42, v42
  v_exp_f32 v43, v43
  v_pk_add_f32 v[36:37], v[36:37], v[56:57]
  v_pk_add_f32 v[38:39], v[38:39], v[56:57]
  v_pk_add_f32 v[40:41], v[40:41], v[56:57]
  v_pk_add_f32 v[42:43], v[42:43], v[56:57]
  v_rcp_f32 v36, v36
  v_rcp_f32 v37, v37
  v_rcp_f32 v38, v38
  v_rcp_f32 v39, v39
  v_rcp_f32 v40, v40
  v_rcp_f32 v41, v41
  v_rcp_f32 v42, v42
  v_rcp_f32 v43, v43
  v_pk_mul_f32 v[96:97], v[96:97], v[36:37]
  v_pk_mul_f32 v[98:99], v[98:99], v[38:39]
  v_pk_mul_f32 v[100:101], v[100:101], v[40:41]
  v_pk_mul_f32 v[102:103], v[102:103], v[42:43]
  v_cvt_pk_bf16_f32 v96, v96, v97
  v_cvt_pk_bf16_f32 v97, v98, v99
  v_cvt_pk_bf16_f32 v98, v100, v101
  v_cvt_pk_bf16_f32 v99, v102, v103
  v_pk_mul_f32 v[36:37], v[104:105], v[104:105]
  v_pk_mul_f32 v[38:39], v[106:107], v[106:107]
  v_pk_mul_f32 v[40:41], v[108:109], v[108:109]
  v_pk_mul_f32 v[42:43], v[110:111], v[110:111]
  v_pk_fma_f32 v[36:37], v[36:37], v[54:55], v[52:53]
  v_pk_fma_f32 v[38:39], v[38:39], v[54:55], v[52:53]
  v_pk_fma_f32 v[40:41], v[40:41], v[54:55], v[52:53]
  v_pk_fma_f32 v[42:43], v[42:43], v[54:55], v[52:53]
  v_pk_mul_f32 v[36:37], v[36:37], v[104:105]
  v_pk_mul_f32 v[38:39], v[38:39], v[106:107]
  v_pk_mul_f32 v[40:41], v[40:41], v[108:109]
  v_pk_mul_f32 v[42:43], v[42:43], v[110:111]
  v_exp_f32 v36, v36
  v_exp_f32 v37, v37
  v_exp_f32 v38, v38
  v_exp_f32 v39, v39
  v_exp_f32 v40, v40
  v_exp_f32 v41, v41
  v_exp_f32 v42, v42
  v_exp_f32 v43, v43
  v_pk_add_f32 v[36:37], v[36:37], v[56:57]
  v_pk_add_f32 v[38:39], v[38:39], v[56:57]
  v_pk_add_f32 v[40:41], v[40:41], v[56:57]
  v_pk_add_f32 v[42:43], v[42:43], v[56:57]
  v_rcp_f32 v36, v36
  v_rcp_f32 v37, v37
  v_rcp_f32 v38, v38
  v_rcp_f32 v39, v39
  v_rcp_f32 v40, v40
  v_rcp_f32 v41, v41
  v_rcp_f32 v42, v42
  v_rcp_f32 v43, v43
  v_pk_mul_f32 v[104:105], v[104:105], v[36:37]
  v_pk_mul_f32 v[106:107], v[106:107], v[38:39]
  v_pk_mul_f32 v[108:109], v[108:109], v[40:41]
  v_pk_mul_f32 v[110:111], v[110:111], v[42:43]
  v_cvt_pk_bf16_f32 v100, v104, v105
  v_cvt_pk_bf16_f32 v101, v106, v107
  v_cvt_pk_bf16_f32 v102, v108, v109
  v_cvt_pk_bf16_f32 v103, v110, v111
  s_add_u32 s61, s100, 2048
  buffer_store_dwordx4 v[96:99], v58, s[8:11], s61 offen sc1
  s_add_u32 s61, s100, 3072
  buffer_store_dwordx4 v[100:103], v58, s[8:11], s61 offen sc1
  v_pk_mul_f32 v[36:37], v[112:113], v[112:113]
  v_pk_mul_f32 v[38:39], v[114:115], v[114:115]
  v_pk_mul_f32 v[40:41], v[116:117], v[116:117]
  v_pk_mul_f32 v[42:43], v[118:119], v[118:119]
  v_pk_fma_f32 v[36:37], v[36:37], v[54:55], v[52:53]
  v_pk_fma_f32 v[38:39], v[38:39], v[54:55], v[52:53]
  v_pk_fma_f32 v[40:41], v[40:41], v[54:55], v[52:53]
  v_pk_fma_f32 v[42:43], v[42:43], v[54:55], v[52:53]
  v_pk_mul_f32 v[36:37], v[36:37], v[112:113]
  v_pk_mul_f32 v[38:39], v[38:39], v[114:115]
  v_pk_mul_f32 v[40:41], v[40:41], v[116:117]
  v_pk_mul_f32 v[42:43], v[42:43], v[118:119]
  v_exp_f32 v36, v36
  v_exp_f32 v37, v37
  v_exp_f32 v38, v38
  v_exp_f32 v39, v39
  v_exp_f32 v40, v40
  v_exp_f32 v41, v41
  v_exp_f32 v42, v42
  v_exp_f32 v43, v43
  v_pk_add_f32 v[36:37], v[36:37], v[56:57]
  v_pk_add_f32 v[38:39], v[38:39], v[56:57]
  v_pk_add_f32 v[40:41], v[40:41], v[56:57]
  v_pk_add_f32 v[42:43], v[42:43], v[56:57]
  v_rcp_f32 v36, v36
  v_rcp_f32 v37, v37
  v_rcp_f32 v38, v38
  v_rcp_f32 v39, v39
  v_rcp_f32 v40, v40
  v_rcp_f32 v41, v41
  v_rcp_f32 v42, v42
  v_rcp_f32 v43, v43
  v_pk_mul_f32 v[112:113], v[112:113], v[36:37]
  v_pk_mul_f32 v[114:115], v[114:115], v[38:39]
  v_pk_mul_f32 v[116:117], v[116:117], v[40:41]
  v_pk_mul_f32 v[118:119], v[118:119], v[42:43]
  v_cvt_pk_bf16_f32 v112, v112, v113
  v_cvt_pk_bf16_f32 v113, v114, v115
  v_cvt_pk_bf16_f32 v114, v116, v117
  v_cvt_pk_bf16_f32 v115, v118, v119
  v_pk_mul_f32 v[36:37], v[120:121], v[120:121]
  v_pk_mul_f32 v[38:39], v[122:123], v[122:123]
  v_pk_mul_f32 v[40:41], v[124:125], v[124:125]
  v_pk_mul_f32 v[42:43], v[126:127], v[126:127]
  v_pk_fma_f32 v[36:37], v[36:37], v[54:55], v[52:53]
  v_pk_fma_f32 v[38:39], v[38:39], v[54:55], v[52:53]
  v_pk_fma_f32 v[40:41], v[40:41], v[54:55], v[52:53]
  v_pk_fma_f32 v[42:43], v[42:43], v[54:55], v[52:53]
  v_pk_mul_f32 v[36:37], v[36:37], v[120:121]
  v_pk_mul_f32 v[38:39], v[38:39], v[122:123]
  v_pk_mul_f32 v[40:41], v[40:41], v[124:125]
  v_pk_mul_f32 v[42:43], v[42:43], v[126:127]
  v_exp_f32 v36, v36
  v_exp_f32 v37, v37
  v_exp_f32 v38, v38
  v_exp_f32 v39, v39
  v_exp_f32 v40, v40
  v_exp_f32 v41, v41
  v_exp_f32 v42, v42
  v_exp_f32 v43, v43
  v_pk_add_f32 v[36:37], v[36:37], v[56:57]
  v_pk_add_f32 v[38:39], v[38:39], v[56:57]
  v_pk_add_f32 v[40:41], v[40:41], v[56:57]
  v_pk_add_f32 v[42:43], v[42:43], v[56:57]
  v_rcp_f32 v36, v36
  v_rcp_f32 v37, v37
  v_rcp_f32 v38, v38
  v_rcp_f32 v39, v39
  v_rcp_f32 v40, v40
  v_rcp_f32 v41, v41
  v_rcp_f32 v42, v42
  v_rcp_f32 v43, v43
  v_pk_mul_f32 v[120:121], v[120:121], v[36:37]
  v_pk_mul_f32 v[122:123], v[122:123], v[38:39]
  v_pk_mul_f32 v[124:125], v[124:125], v[40:41]
  v_pk_mul_f32 v[126:127], v[126:127], v[42:43]
  v_cvt_pk_bf16_f32 v116, v120, v121
  v_cvt_pk_bf16_f32 v117, v122, v123
  v_cvt_pk_bf16_f32 v118, v124, v125
  v_cvt_pk_bf16_f32 v119, v126, v127
  s_add_u32 s61, s100, 112640
  buffer_store_dwordx4 v[112:115], v58, s[8:11], s61 offen sc1
  s_add_u32 s61, s100, 113664
  buffer_store_dwordx4 v[116:119], v58, s[8:11], s61 offen sc1
  s_branch L_Bpost
L_Bf3:
  s_cmp_ge_u32 s48, 6
  s_cbranch_scc1 L_BnoF
  v_bfe_u32 v52, v1, 2, 2
  v_and_b32 v53, 3, v1
  v_bfe_u32 v54, v1, 4, 1
  v_lshlrev_b32 v53, 3, v53
  v_lshl_add_u32 v53, v54, 5, v53
  v_lshl_add_u32 v55, v2, 3, v52
  v_mul_u32_u24 v60, 1280, v3
  v_and_b32 v61, 15, v3
  v_xor_b32 v61, v61, v2
  v_lshlrev_b32 v61, 4, v61
  v_xor_b32 v10, 0, v61
  v_add_u32 v10, v10, v60
  v_xor_b32 v11, 32, v61
  v_add_u32 v11, v11, v60
  v_xor_b32 v12, 64, v61
  v_add_u32 v12, v12, v60
  v_xor_b32 v13, 96, v61
  v_add_u32 v13, v13, v60
  v_xor_b32 v14, 128, v61
  v_add_u32 v14, v14, v60
  v_xor_b32 v15, 160, v61
  v_add_u32 v15, v15, v60
  v_xor_b32 v16, 192, v61
  v_add_u32 v16, v16, v60
  v_xor_b32 v17, 224, v61
  v_add_u32 v17, v17, v60
  s_mov_b32 s12, s32
  s_and_b32 s13, s33, 0xffff
  s_mov_b32 s14, 0x21c000
  s_mov_b32 s15, 0x00020000
  s_lshl_b32 s51, s59, 6
  s_mov_b32 s53, 55296
  s_mov_b32 s56, 118784
  v_lshrrev_b32 v56, 2, v1
  v_mul_u32_u24 v56, 3456, v56
  v_and_b32 v57, 3, v1
  v_lshl_add_u32 v18, v57, 4, v56
  v_lshl_add_u32 v19, v55, 6, v53
  v_add_u32 v19, s56, v19
  s_add_u32 m0, s56, 0
  s_nop 0
  buffer_load_dwordx4 v18, s[12:15], s51 offen lds
  s_add_u32 s51, s51, s53
  s_add_u32 m0, s56, 1024
  s_nop 0
  buffer_load_dwordx4 v18, s[12:15], s51 offen lds
  s_add_u32 s51, s51, s53
  s_add_u32 m0, s56, 2048
  s_nop 0
  buffer_load_dwordx4 v18, s[12:15], s51 offen lds
  s_add_u32 s51, s51, s53
  s_add_u32 m0, s56, 3072
  s_nop 0
  buffer_load_dwordx4 v18, s[12:15], s51 offen lds
  s_add_u32 s51, s51, s53
  s_add_u32 m0, s56, 4096
  s_nop 0
  buffer_load_dwordx4 v18, s[12:15], s51 offen lds
  s_add_u32 s51, s51, s53
  s_add_u32 m0, s56, 5120
  s_nop 0
  buffer_load_dwordx4 v18, s[12:15], s51 offen lds
  s_add_u32 s51, s51, s53
  s_lshl_b32 s60, s76, 7
  s_add_u32 s60, s60, 163072
  v_lshlrev_b32 v158, 3, v2
  v_add_u32 v158, s60, v158
  ds_read_b64 v[128:129], v158 offset:0
  ds_read_b64 v[130:131], v158 offset:16
  ds_read_b64 v[132:133], v158 offset:32
  ds_read_b64 v[134:135], v158 offset:48
  ds_read_b64 v[136:137], v158 offset:64
  ds_read_b64 v[138:139], v158 offset:80
  ds_read_b64 v[140:141], v158 offset:96
  ds_read_b64 v[142:143], v158 offset:112
  s_waitcnt lgkmcnt(0)
  v_lshlrev_b32 v64, 16, v128
  v_and_b32 v65, 0xffff0000, v128
  v_lshlrev_b32 v80, 16, v128
  v_and_b32 v81, 0xffff0000, v128
  v_lshlrev_b32 v66, 16, v129
  v_and_b32 v67, 0xffff0000, v129
  v_lshlrev_b32 v82, 16, v129
  v_and_b32 v83, 0xffff0000, v129
  v_lshlrev_b32 v68, 16, v130
  v_and_b32 v69, 0xffff0000, v130
  v_lshlrev_b32 v84, 16, v130
  v_and_b32 v85, 0xffff0000, v130
  v_lshlrev_b32 v70, 16, v131
  v_and_b32 v71, 0xffff0000, v131
  v_lshlrev_b32 v86, 16, v131
  v_and_b32 v87, 0xffff0000, v131
  v_lshlrev_b32 v72, 16, v132
  v_and_b32 v73, 0xffff0000, v132
  v_lshlrev_b32 v88, 16, v132
  v_and_b32 v89, 0xffff0000, v132
  v_lshlrev_b32 v74, 16, v133
  v_and_b32 v75, 0xffff0000, v133
  v_lshlrev_b32 v90, 16, v133
  v_and_b32 v91, 0xffff0000, v133
  v_lshlrev_b32 v76, 16, v134
  v_and_b32 v77, 0xffff0000, v134
  v_lshlrev_b32 v92, 16, v134
  v_and_b32 v93, 0xffff0000, v134
  v_lshlrev_b32 v78, 16, v135
  v_and_b32 v79, 0xffff0000, v135
  v_lshlrev_b32 v94, 16, v135
  v_and_b32 v95, 0xffff0000, v135
  s_waitcnt vmcnt(5)
  ds_read_b128 v[36:39], v10 offset:0
  ds_read_b128 v[40:43], v10 offset:40960
  ds_read_b64_tr_b16 v[20:21], v19 offset:0
  ds_read_b64_tr_b16 v[22:23], v19 offset:256
  s_waitcnt lgkmcnt(0)
  s_waitcnt vmcnt(4)
  v_mfma_f32_32x32x16_bf16 v[64:79], v[20:23], v[36:39], v[64:79]
  ds_read_b128 v[44:47], v11 offset:0
  ds_read_b128 v[48:51], v11 offset:40960
  s_add_u32 m0, s56, 0
  s_nop 0
  buffer_load_dwordx4 v18, s[12:15], s51 offen lds
  s_add_u32 s51, s51, s53
  v_mfma_f32_32x32x16_bf16 v[80:95], v[20:23], v[40:43], v[80:95]
  ds_read_b64_tr_b16 v[28:29], v19 offset:1024
  ds_read_b64_tr_b16 v[30:31], v19 offset:1280
  s_waitcnt lgkmcnt(0)
  s_waitcnt vmcnt(4)
  v_mfma_f32_32x32x16_bf16 v[64:79], v[28:31], v[44:47], v[64:79]
  ds_read_b128 v[36:39], v12 offset:0
  ds_read_b128 v[40:43], v12 offset:40960
  s_add_u32 m0, s56, 1024
  s_nop 0
  buffer_load_dwordx4 v18, s[12:15], s51 offen lds
  s_add_u32 s51, s51, s53
  v_mfma_f32_32x32x16_bf16 v[80:95], v[28:31], v[48:51], v[80:95]
  ds_read_b64_tr_b16 v[20:21], v19 offset:2048
  ds_read_b64_tr_b16 v[22:23], v19 offset:2304
  s_waitcnt lgkmcnt(0)
  s_waitcnt vmcnt(4)
  v_mfma_f32_32x32x16_bf16 v[64:79], v[20:23], v[36:39], v[64:79]
  ds_read_b128 v[44:47], v13 offset:0
  ds_read_b128 v[48:51], v13 offset:40960
  s_add_u32 m0, s56, 2048
  s_nop 0
  buffer_load_dwordx4 v18, s[12:15], s51 offen lds
  s_add_u32 s51, s51, s53
  v_mfma_f32_32x32x16_bf16 v[80:95], v[20:23], v[40:43], v[80:95]
  ds_read_b64_tr_b16 v[28:29], v19 offset:3072
  ds_read_b64_tr_b16 v[30:31], v19 offset:3328
  s_waitcnt lgkmcnt(0)
  s_waitcnt vmcnt(4)
  v_mfma_f32_32x32x16_bf16 v[64:79], v[28:31], v[44:47], v[64:79]
  ds_read_b128 v[36:39], v14 offset:0
  ds_read_b128 v[40:43], v14 offset:40960
  s_add_u32 m0, s56, 3072
  s_nop 0
  buffer_load_dwordx4 v18, s[12:15], s51 offen lds
  s_add_u32 s51, s51, s53
  v_mfma_f32_32x32x16_bf16 v[80:95], v[28:31], v[48:51], v[80:95]
  ds_read_b64_tr_b16 v[20:21], v19 offset:4096
  ds_read_b64_tr_b16 v[22:23], v19 offset:4352
  s_waitcnt lgkmcnt(0)
  s_waitcnt vmcnt(4)
  v_mfma_f32_32x32x16_bf16 v[64:79], v[20:23], v[36:39], v[64:79]
  ds_read_b128 v[44:47], v15 offset:0
  ds_read_b128 v[48:51], v15 offset:40960
  s_add_u32 m0, s56, 4096
  s_nop 0
  buffer_load_dwordx4 v18, s[12:15], s51 offen lds
  s_add_u32 s51, s51, s53
  v_mfma_f32_32x32x16_bf16 v[80:95], v[20:23], v[40:43], v[80:95]
  ds_read_b64_tr_b16 v[28:29], v19 offset:5120
  ds_read_b64_tr_b16 v[30:31], v19 offset:5376
  s_waitcnt lgkmcnt(0)
  s_waitcnt vmcnt(4)
  v_mfma_f32_32x32x16_bf16 v[64:79], v[28:31], v[44:47], v[64:79]
  ds_read_b128 v[36:39], v16 offset:0
  ds_read_b128 v[40:43], v16 offset:40960
  s_add_u32 m0, s56, 5120
  s_nop 0
  buffer_load_dwordx4 v18, s[12:15], s51 offen lds
  s_add_u32 s51, s51, s53
  v_mfma_f32_32x32x16_bf16 v[80:95], v[28:31], v[48:51], v[80:95]
  ds_read_b64_tr_b16 v[20:21], v19 offset:0
  ds_read_b64_tr_b16 v[22:23], v19 offset:256
  s_waitcnt lgkmcnt(0)
  s_waitcnt vmcnt(4)
  v_mfma_f32_32x32x16_bf16 v[64:79], v[20:23], v[36:39], v[64:79]
  ds_read_b128 v[44:47], v17 offset:0
  ds_read_b128 v[48:51], v17 offset:40960
  s_add_u32 m0, s56, 0
  s_nop 0
  buffer_load_dwordx4 v18, s[12:15], s51 offen lds
  s_add_u32 s51, s51, s53
  v_mfma_f32_32x32x16_bf16 v[80:95], v[20:23], v[40:43], v[80:95]
  ds_read_b64_tr_b16 v[28:29], v19 offset:1024
  ds_read_b64_tr_b16 v[30:31], v19 offset:1280
  s_waitcnt lgkmcnt(0)
  s_waitcnt vmcnt(4)
  v_mfma_f32_32x32x16_bf16 v[64:79], v[28:31], v[44:47], v[64:79]
  ds_read_b128 v[36:39], v10 offset:256
  ds_read_b128 v[40:43], v10 offset:41216
  s_add_u32 m0, s56, 1024
  s_nop 0
  buffer_load_dwordx4 v18, s[12:15], s51 offen lds
  s_add_u32 s51, s51, s53
  v_mfma_f32_32x32x16_bf16 v[80:95], v[28:31], v[48:51], v[80:95]
  ds_read_b64_tr_b16 v[20:21], v19 offset:2048
  ds_read_b64_tr_b16 v[22:23], v19 offset:2304
  s_waitcnt lgkmcnt(0)
  s_waitcnt vmcnt(4)
  v_mfma_f32_32x32x16_bf16 v[64:79], v[20:23], v[36:39], v[64:79]
  ds_read_b128 v[44:47], v11 offset:256
  ds_read_b128 v[48:51], v11 offset:41216
  s_add_u32 m0, s56, 2048
  s_nop 0
  buffer_load_dwordx4 v18, s[12:15], s51 offen lds
  s_add_u32 s51, s51, s53
  v_mfma_f32_32x32x16_bf16 v[80:95], v[20:23], v[40:43], v[80:95]
  ds_read_b64_tr_b16 v[28:29], v19 offset:3072
  ds_read_b64_tr_b16 v[30:31], v19 offset:3328
  s_waitcnt lgkmcnt(0)
  s_waitcnt vmcnt(4)
  v_mfma_f32_32x32x16_bf16 v[64:79], v[28:31], v[44:47], v[64:79]
  ds_read_b128 v[36:39], v12 offset:256
  ds_read_b128 v[40:43], v12 offset:41216
  s_add_u32 m0, s56, 3072
  s_nop 0
  buffer_load_dwordx4 v18, s[12:15], s51 offen lds
  s_add_u32 s51, s51, s53
  v_mfma_f32_32x32x16_bf16 v[80:95], v[28:31], v[48:51], v[80:95]
  ds_read_b64_tr_b16 v[20:21], v19 offset:4096
  ds_read_b64_tr_b16 v[22:23], v19 offset:4352
  s_waitcnt lgkmcnt(0)
  s_waitcnt vmcnt(4)
  v_mfma_f32_32x32x16_bf16 v[64:79], v[20:23], v[36:39], v[64:79]
  ds_read_b128 v[44:47], v13 offset:256
  ds_read_b128 v[48:51], v13 offset:41216
  s_add_u32 m0, s56, 4096
  s_nop 0
  buffer_load_dwordx4 v18, s[12:15], s51 offen lds
  s_add_u32 s51, s51, s53
  v_mfma_f32_32x32x16_bf16 v[80:95], v[20:23], v[40:43], v[80:95]
  ds_read_b64_tr_b16 v[28:29], v19 offset:5120
  ds_read_b64_tr_b16 v[30:31], v19 offset:5376
  s_waitcnt lgkmcnt(0)
  s_waitcnt vmcnt(4)
  v_mfma_f32_32x32x16_bf16 v[64:79], v[28:31], v[44:47], v[64:79]
  ds_read_b128 v[36:39], v14 offset:256
  ds_read_b128 v[40:43], v14 offset:41216
  s_add_u32 m0, s56, 5120
  s_nop 0
  buffer_load_dwordx4 v18, s[12:15], s51 offen lds
  s_add_u32 s51, s51, s53
  v_mfma_f32_32x32x16_bf16 v[80:95], v[28:31], v[48:51], v[80:95]
  ds_read_b64_tr_b16 v[20:21], v19 offset:0
  ds_read_b64_tr_b16 v[22:23], v19 offset:256
  s_waitcnt lgkmcnt(0)
  s_waitcnt vmcnt(4)
  v_mfma_f32_32x32x16_bf16 v[64:79], v[20:23], v[36:39], v[64:79]
  ds_read_b128 v[44:47], v15 offset:256
  ds_read_b128 v[48:51], v15 offset:41216
  s_add_u32 m0, s56, 0
  s_nop 0
  buffer_load_dwordx4 v18, s[12:15], s51 offen lds
  s_add_u32 s51, s51, s53
  v_mfma_f32_32x32x16_bf16 v[80:95], v[20:23], v[40:43], v[80:95]
  ds_read_b64_tr_b16 v[28:29], v19 offset:1024
  ds_read_b64_tr_b16 v[30:31], v19 offset:1280
  s_waitcnt lgkmcnt(0)
  s_waitcnt vmcnt(4)
  v_mfma_f32_32x32x16_bf16 v[64:79], v[28:31], v[44:47], v[64:79]
  ds_read_b128 v[36:39], v16 offset:256
  ds_read_b128 v[40:43], v16 offset:41216
  s_add_u32 m0, s56, 1024
  s_nop 0
  buffer_load_dwordx4 v18, s[12:15], s51 offen lds
  s_add_u32 s51, s51, s53
  v_mfma_f32_32x32x16_bf16 v[80:95], v[28:31], v[48:51], v[80:95]
  ds_read_b64_tr_b16 v[20:21], v19 offset:2048
  ds_read_b64_tr_b16 v[22:23], v19 offset:2304
  s_waitcnt lgkmcnt(0)
  s_waitcnt vmcnt(4)
  v_mfma_f32_32x32x16_bf16 v[64:79], v[20:23], v[36:39], v[64:79]
  ds_read_b128 v[44:47], v17 offset:256
  ds_read_b128 v[48:51], v17 offset:41216
  s_add_u32 m0, s56, 2048
  s_nop 0
  buffer_load_dwordx4 v18, s[12:15], s51 offen lds
  s_add_u32 s51, s51, s53
  v_mfma_f32_32x32x16_bf16 v[80:95], v[20:23], v[40:43], v[80:95]
  ds_read_b64_tr_b16 v[28:29], v19 offset:3072
  ds_read_b64_tr_b16 v[30:31], v19 offset:3328
  s_waitcnt lgkmcnt(0)
  s_waitcnt vmcnt(4)
  v_mfma_f32_32x32x16_bf16 v[64:79], v[28:31], v[44:47], v[64:79]
  ds_read_b128 v[36:39], v10 offset:512
  ds_read_b128 v[40:43], v10 offset:41472
  s_add_u32 m0, s56, 3072
  s_nop 0
  buffer_load_dwordx4 v18, s[12:15], s51 offen lds
  s_add_u32 s51, s51, s53
  v_mfma_f32_32x32x16_bf16 v[80:95], v[28:31], v[48:51], v[80:95]
  ds_read_b64_tr_b16 v[20:21], v19 offset:4096
  ds_read_b64_tr_b16 v[22:23], v19 offset:4352
  s_waitcnt lgkmcnt(0)
  s_waitcnt vmcnt(4)
  v_mfma_f32_32x32x16_bf16 v[64:79], v[20:23], v[36:39], v[64:79]
  ds_read_b128 v[44:47], v11 offset:512
  ds_read_b128 v[48:51], v11 offset:41472
  s_add_u32 m0, s56, 4096
  s_nop 0
  buffer_load_dwordx4 v18, s[12:15], s51 offen lds
  s_add_u32 s51, s51, s53
  v_mfma_f32_32x32x16_bf16 v[80:95], v[20:23], v[40:43], v[80:95]
  ds_read_b64_tr_b16 v[28:29], v19 offset:5120
  ds_read_b64_tr_b16 v[30:31], v19 offset:5376
  s_waitcnt lgkmcnt(0)
  s_waitcnt vmcnt(4)
  v_mfma_f32_32x32x16_bf16 v[64:79], v[28:31], v[44:47], v[64:79]
  ds_read_b128 v[36:39], v12 offset:512
  ds_read_b128 v[40:43], v12 offset:41472
  s_add_u32 m0, s56, 5120
  s_nop 0
  buffer_load_dwordx4 v18, s[12:15], s51 offen lds
  s_add_u32 s51, s51, s53
  v_mfma_f32_32x32x16_bf16 v[80:95], v[28:31], v[48:51], v[80:95]
  ds_read_b64_tr_b16 v[20:21], v19 offset:0
  ds_read_b64_tr_b16 v[22:23], v19 offset:256
  s_waitcnt lgkmcnt(0)
  s_waitcnt vmcnt(4)
  v_mfma_f32_32x32x16_bf16 v[64:79], v[20:23], v[36:39], v[64:79]
  ds_read_b128 v[44:47], v13 offset:512
  ds_read_b128 v[48:51], v13 offset:41472
  s_add_u32 m0, s56, 0
  s_nop 0
  buffer_load_dwordx4 v18, s[12:15], s51 offen lds
  s_add_u32 s51, s51, s53
  v_mfma_f32_32x32x16_bf16 v[80:95], v[20:23], v[40:43], v[80:95]
  ds_read_b64_tr_b16 v[28:29], v19 offset:1024
  ds_read_b64_tr_b16 v[30:31], v19 offset:1280
  s_waitcnt lgkmcnt(0)
  s_waitcnt vmcnt(4)
  v_mfma_f32_32x32x16_bf16 v[64:79], v[28:31], v[44:47], v[64:79]
  ds_read_b128 v[36:39], v14 offset:512
  ds_read_b128 v[40:43], v14 offset:41472
  s_add_u32 m0, s56, 1024
  s_nop 0
  buffer_load_dwordx4 v18, s[12:15], s51 offen lds
  s_add_u32 s51, s51, s53
  v_mfma_f32_32x32x16_bf16 v[80:95], v[28:31], v[48:51], v[80:95]
  ds_read_b64_tr_b16 v[20:21], v19 offset:2048
  ds_read_b64_tr_b16 v[22:23], v19 offset:2304
  s_waitcnt lgkmcnt(0)
  s_waitcnt vmcnt(4)
  v_mfma_f32_32x32x16_bf16 v[64:79], v[20:23], v[36:39], v[64:79]
  ds_read_b128 v[44:47], v15 offset:512
  ds_read_b128 v[48:51], v15 offset:41472
  s_add_u32 m0, s56, 2048
  s_nop 0
  buffer_load_dwordx4 v18, s[12:15], s51 offen lds
  s_add_u32 s51, s51, s53
  v_mfma_f32_32x32x16_bf16 v[80:95], v[20:23], v[40:43], v[80:95]
  ds_read_b64_tr_b16 v[28:29], v19 offset:3072
  ds_read_b64_tr_b16 v[30:31], v19 offset:3328
  s_waitcnt lgkmcnt(0)
  s_waitcnt vmcnt(4)
  v_mfma_f32_32x32x16_bf16 v[64:79], v[28:31], v[44:47], v[64:79]
  ds_read_b128 v[36:39], v16 offset:512
  ds_read_b128 v[40:43], v16 offset:41472
  s_add_u32 m0, s56, 3072
  s_nop 0
  buffer_load_dwordx4 v18, s[12:15], s51 offen lds
  s_add_u32 s51, s51, s53
  v_mfma_f32_32x32x16_bf16 v[80:95], v[28:31], v[48:51], v[80:95]
  ds_read_b64_tr_b16 v[20:21], v19 offset:4096
  ds_read_b64_tr_b16 v[22:23], v19 offset:4352
  s_waitcnt lgkmcnt(0)
  s_waitcnt vmcnt(4)
  v_mfma_f32_32x32x16_bf16 v[64:79], v[20:23], v[36:39], v[64:79]
  ds_read_b128 v[44:47], v17 offset:512
  ds_read_b128 v[48:51], v17 offset:41472
  s_add_u32 m0, s56, 4096
  s_nop 0
  buffer_load_dwordx4 v18, s[12:15], s51 offen lds
  s_add_u32 s51, s51, s53
  v_mfma_f32_32x32x16_bf16 v[80:95], v[20:23], v[40:43], v[80:95]
  ds_read_b64_tr_b16 v[28:29], v19 offset:5120
  ds_read_b64_tr_b16 v[30:31], v19 offset:5376
  s_waitcnt lgkmcnt(0)
  s_waitcnt vmcnt(4)
  v_mfma_f32_32x32x16_bf16 v[64:79], v[28:31], v[44:47], v[64:79]
  ds_read_b128 v[36:39], v10 offset:768
  ds_read_b128 v[40:43], v10 offset:41728
  s_add_u32 m0, s56, 5120
  s_nop 0
  buffer_load_dwordx4 v18, s[12:15], s51 offen lds
  s_add_u32 s51, s51, s53
  v_mfma_f32_32x32x16_bf16 v[80:95], v[28:31], v[48:51], v[80:95]
  ds_read_b64_tr_b16 v[20:21], v19 offset:0
  ds_read_b64_tr_b16 v[22:23], v19 offset:256
  s_waitcnt lgkmcnt(0)
  s_waitcnt vmcnt(4)
  v_mfma_f32_32x32x16_bf16 v[64:79], v[20:23], v[36:39], v[64:79]
  ds_read_b128 v[44:47], v11 offset:768
  ds_read_b128 v[48:51], v11 offset:41728
  s_add_u32 m0, s56, 0
  s_nop 0
  buffer_load_dwordx4 v18, s[12:15], s51 offen lds
  s_add_u32 s51, s51, s53
  v_mfma_f32_32x32x16_bf16 v[80:95], v[20:23], v[40:43], v[80:95]
  ds_read_b64_tr_b16 v[28:29], v19 offset:1024
  ds_read_b64_tr_b16 v[30:31], v19 offset:1280
  s_waitcnt lgkmcnt(0)
  s_waitcnt vmcnt(4)
  v_mfma_f32_32x32x16_bf16 v[64:79], v[28:31], v[44:47], v[64:79]
  ds_read_b128 v[36:39], v12 offset:768
  ds_read_b128 v[40:43], v12 offset:41728
  s_add_u32 m0, s56, 1024
  s_nop 0
  buffer_load_dwordx4 v18, s[12:15], s51 offen lds
  s_add_u32 s51, s51, s53
  v_mfma_f32_32x32x16_bf16 v[80:95], v[28:31], v[48:51], v[80:95]
  ds_read_b64_tr_b16 v[20:21], v19 offset:2048
  ds_read_b64_tr_b16 v[22:23], v19 offset:2304
  s_waitcnt lgkmcnt(0)
  s_waitcnt vmcnt(4)
  v_mfma_f32_32x32x16_bf16 v[64:79], v[20:23], v[36:39], v[64:79]
  ds_read_b128 v[44:47], v13 offset:768
  ds_read_b128 v[48:51], v13 offset:41728
  s_add_u32 m0, s56, 2048
  s_nop 0
  buffer_load_dwordx4 v18, s[12:15], s51 offen lds
  s_add_u32 s51, s51, s53
  v_mfma_f32_32x32x16_bf16 v[80:95], v[20:23], v[40:43], v[80:95]
  ds_read_b64_tr_b16 v[28:29], v19 offset:3072
  ds_read_b64_tr_b16 v[30:31], v19 offset:3328
  s_waitcnt lgkmcnt(0)
  s_waitcnt vmcnt(4)
  v_mfma_f32_32x32x16_bf16 v[64:79], v[28:31], v[44:47], v[64:79]
  ds_read_b128 v[36:39], v14 offset:768
  ds_read_b128 v[40:43], v14 offset:41728
  s_add_u32 m0, s56, 3072
  s_nop 0
  buffer_load_dwordx4 v18, s[12:15], s51 offen lds
  s_add_u32 s51, s51, s53
  v_mfma_f32_32x32x16_bf16 v[80:95], v[28:31], v[48:51], v[80:95]
  ds_read_b64_tr_b16 v[20:21], v19 offset:4096
  ds_read_b64_tr_b16 v[22:23], v19 offset:4352
  s_waitcnt lgkmcnt(0)
  s_waitcnt vmcnt(4)
  v_mfma_f32_32x32x16_bf16 v[64:79], v[20:23], v[36:39], v[64:79]
  ds_read_b128 v[44:47], v15 offset:768
  ds_read_b128 v[48:51], v15 offset:41728
  s_add_u32 m0, s56, 4096
  s_nop 0
  buffer_load_dwordx4 v18, s[12:15], s51 offen lds
  s_add_u32 s51, s51, s53
  v_mfma_f32_32x32x16_bf16 v[80:95], v[20:23], v[40:43], v[80:95]
  ds_read_b64_tr_b16 v[28:29], v19 offset:5120
  ds_read_b64_tr_b16 v[30:31], v19 offset:5376
  s_waitcnt lgkmcnt(0)
  s_waitcnt vmcnt(4)
  v_mfma_f32_32x32x16_bf16 v[64:79], v[28:31], v[44:47], v[64:79]
  ds_read_b128 v[36:39], v16 offset:768
  ds_read_b128 v[40:43], v16 offset:41728
  s_add_u32 m0, s56, 5120
  s_nop 0
  buffer_load_dwordx4 v18, s[12:15], s51 offen lds
  s_add_u32 s51, s51, s53
  v_mfma_f32_32x32x16_bf16 v[80:95], v[28:31], v[48:51], v[80:95]
  ds_read_b64_tr_b16 v[20:21], v19 offset:0
  ds_read_b64_tr_b16 v[22:23], v19 offset:256
  s_waitcnt lgkmcnt(0)
  s_waitcnt vmcnt(4)
  v_mfma_f32_32x32x16_bf16 v[64:79], v[20:23], v[36:39], v[64:79]
  ds_read_b128 v[44:47], v17 offset:768
  ds_read_b128 v[48:51], v17 offset:41728
  s_add_u32 m0, s56, 0
  s_nop 0
  buffer_load_dwordx4 v18, s[12:15], s51 offen lds
  s_add_u32 s51, s51, s53
  v_mfma_f32_32x32x16_bf16 v[80:95], v[20:23], v[40:43], v[80:95]
  ds_read_b64_tr_b16 v[28:29], v19 offset:1024
  ds_read_b64_tr_b16 v[30:31], v19 offset:1280
  s_waitcnt lgkmcnt(0)
  s_waitcnt vmcnt(4)
  v_mfma_f32_32x32x16_bf16 v[64:79], v[28:31], v[44:47], v[64:79]
  ds_read_b128 v[36:39], v10 offset:1024
  ds_read_b128 v[40:43], v10 offset:41984
  s_add_u32 m0, s56, 1024
  s_nop 0
  buffer_load_dwordx4 v18, s[12:15], s51 offen lds
  s_add_u32 s51, s51, s53
  v_mfma_f32_32x32x16_bf16 v[80:95], v[28:31], v[48:51], v[80:95]
  ds_read_b64_tr_b16 v[20:21], v19 offset:2048
  ds_read_b64_tr_b16 v[22:23], v19 offset:2304
  s_waitcnt lgkmcnt(0)
  s_waitcnt vmcnt(4)
  v_mfma_f32_32x32x16_bf16 v[64:79], v[20:23], v[36:39], v[64:79]
  ds_read_b128 v[44:47], v11 offset:1024
  ds_read_b128 v[48:51], v11 offset:41984
  s_add_u32 m0, s56, 2048
  s_nop 0
  buffer_load_dwordx4 v18, s[12:15], s51 offen lds
  s_add_u32 s51, s51, s53
  v_mfma_f32_32x32x16_bf16 v[80:95], v[20:23], v[40:43], v[80:95]
  ds_read_b64_tr_b16 v[28:29], v19 offset:3072
  ds_read_b64_tr_b16 v[30:31], v19 offset:3328
  s_waitcnt lgkmcnt(0)
  s_waitcnt vmcnt(4)
  v_mfma_f32_32x32x16_bf16 v[64:79], v[28:31], v[44:47], v[64:79]
  ds_read_b128 v[36:39], v12 offset:1024
  ds_read_b128 v[40:43], v12 offset:41984
  s_add_u32 m0, s56, 3072
  s_nop 0
  buffer_load_dwordx4 v18, s[12:15], s51 offen lds
  s_add_u32 s51, s51, s53
  v_mfma_f32_32x32x16_bf16 v[80:95], v[28:31], v[48:51], v[80:95]
  ds_read_b64_tr_b16 v[20:21], v19 offset:4096
  ds_read_b64_tr_b16 v[22:23], v19 offset:4352
  s_waitcnt lgkmcnt(0)
  s_waitcnt vmcnt(4)
  v_mfma_f32_32x32x16_bf16 v[64:79], v[20:23], v[36:39], v[64:79]
  ds_read_b128 v[44:47], v13 offset:1024
  ds_read_b128 v[48:51], v13 offset:41984
  v_mfma_f32_32x32x16_bf16 v[80:95], v[20:23], v[40:43], v[80:95]
  ds_read_b64_tr_b16 v[28:29], v19 offset:5120
  ds_read_b64_tr_b16 v[30:31], v19 offset:5376
  s_waitcnt lgkmcnt(0)
  s_waitcnt vmcnt(3)
  v_mfma_f32_32x32x16_bf16 v[64:79], v[28:31], v[44:47], v[64:79]
  ds_read_b128 v[36:39], v14 offset:1024
  ds_read_b128 v[40:43], v14 offset:41984
  v_mfma_f32_32x32x16_bf16 v[80:95], v[28:31], v[48:51], v[80:95]
  ds_read_b64_tr_b16 v[20:21], v19 offset:0
  ds_read_b64_tr_b16 v[22:23], v19 offset:256
  s_waitcnt lgkmcnt(0)
  s_waitcnt vmcnt(2)
  v_mfma_f32_32x32x16_bf16 v[64:79], v[20:23], v[36:39], v[64:79]
  ds_read_b128 v[44:47], v15 offset:1024
  ds_read_b128 v[48:51], v15 offset:41984
  v_mfma_f32_32x32x16_bf16 v[80:95], v[20:23], v[40:43], v[80:95]
  ds_read_b64_tr_b16 v[28:29], v19 offset:1024
  ds_read_b64_tr_b16 v[30:31], v19 offset:1280
  s_waitcnt lgkmcnt(0)
  s_waitcnt vmcnt(1)
  v_mfma_f32_32x32x16_bf16 v[64:79], v[28:31], v[44:47], v[64:79]
  ds_read_b128 v[36:39], v16 offset:1024
  ds_read_b128 v[40:43], v16 offset:41984
  v_mfma_f32_32x32x16_bf16 v[80:95], v[28:31], v[48:51], v[80:95]
  ds_read_b64_tr_b16 v[20:21], v19 offset:2048
  ds_read_b64_tr_b16 v[22:23], v19 offset:2304
  s_waitcnt lgkmcnt(0)
  s_waitcnt vmcnt(0)
  v_mfma_f32_32x32x16_bf16 v[64:79], v[20:23], v[36:39], v[64:79]
  ds_read_b128 v[44:47], v17 offset:1024
  ds_read_b128 v[48:51], v17 offset:41984
  v_mfma_f32_32x32x16_bf16 v[80:95], v[20:23], v[40:43], v[80:95]
  ds_read_b64_tr_b16 v[28:29], v19 offset:3072
  ds_read_b64_tr_b16 v[30:31], v19 offset:3328
  s_waitcnt lgkmcnt(0)
  v_mfma_f32_32x32x16_bf16 v[64:79], v[28:31], v[44:47], v[64:79]
  v_mfma_f32_32x32x16_bf16 v[80:95], v[28:31], v[48:51], v[80:95]
  s_nop 15
  s_lshr_b32 s60, s2, 3
  s_and_b32 s61, s2, 1
  s_sub_u32 s62, s46, 4
  s_mul_i32 s63, s60, 54
  s_mul_i32 s68, s62, 14
  s_add_u32 s63, s63, s68
  s_mul_i32 s68, s61, 640
  s_mov_b32 s16, s36
  s_and_b32 s17, s37, 0xffff
  s_mov_b32 s18, 0x21c000
  s_mov_b32 s19, 0x00020000
  v_lshrrev_b32 v60, 3, v1
  v_and_b32 v61, 7, v1
  v_min_u32 v61, 5, v61
  v_add_u32 v60, s63, v60
  v_mul_u32_u24 v60, 1280, v60
  v_lshl_add_u32 v60, v61, 7, v60
  buffer_load_dword v159, v60, s[16:19], s68 offen
  s_add_u32 s63, s63, 8
  s_mov_b32 s16, s36
  s_and_b32 s17, s37, 0xffff
  s_mov_b32 s18, 0x21c000
  s_mov_b32 s19, 0x00020000
  v_lshrrev_b32 v60, 3, v1
  v_and_b32 v61, 7, v1
  v_min_u32 v61, 5, v61
  v_add_u32 v60, s63, v60
  v_mul_u32_u24 v60, 1280, v60
  v_lshl_add_u32 v60, v61, 7, v60
  buffer_load_dword v159, v60, s[16:19], s68 offen
  s_mul_i32 s63, s60, 20
  s_mul_i32 s62, s62, 5
  s_add_u32 s63, s63, s62
  s_mov_b32 s16, s28
  s_and_b32 s17, s29, 0xffff
  s_mov_b32 s18, 0xc8000
  s_mov_b32 s19, 0x00020000
  v_lshrrev_b32 v60, 3, v1
  v_and_b32 v61, 7, v1
  v_min_u32 v61, 5, v61
  v_add_u32 v60, s63, v60
  v_mul_u32_u24 v60, 1280, v60
  v_lshl_add_u32 v60, v61, 7, v60
  buffer_load_dword v159, v60, s[16:19], s68 offen
  v_mov_b32 v52, 0xc0135761
  v_mov_b32 v54, 0xbdd2d3e8
  v_mov_b32 v56, 1.0
  v_mov_b32 v53, 0xc0135761
  v_mov_b32 v55, 0xbdd2d3e8
  v_mov_b32 v57, 1.0
  s_mul_i32 s60, s47, 221184
  s_lshl_b32 s61, s59, 11
  s_add_u32 s100, s60, s61
  s_add_u32 s100, s100, 524288
  v_lshlrev_b32 v58, 4, v1
  v_pk_mul_f32 v[36:37], v[64:65], v[64:65]
  v_pk_mul_f32 v[38:39], v[66:67], v[66:67]
  v_pk_mul_f32 v[40:41], v[68:69], v[68:69]
  v_pk_mul_f32 v[42:43], v[70:71], v[70:71]
  v_pk_fma_f32 v[36:37], v[36:37], v[54:55], v[52:53]
  v_pk_fma_f32 v[38:39], v[38:39], v[54:55], v[52:53]
  v_pk_fma_f32 v[40:41], v[40:41], v[54:55], v[52:53]
  v_pk_fma_f32 v[42:43], v[42:43], v[54:55], v[52:53]
  v_pk_mul_f32 v[36:37], v[36:37], v[64:65]
  v_pk_mul_f32 v[38:39], v[38:39], v[66:67]
  v_pk_mul_f32 v[40:41], v[40:41], v[68:69]
  v_pk_mul_f32 v[42:43], v[42:43], v[70:71]
  v_exp_f32 v36, v36
  v_exp_f32 v37, v37
  v_exp_f32 v38, v38
  v_exp_f32 v39, v39
  v_exp_f32 v40, v40
  v_exp_f32 v41, v41
  v_exp_f32 v42, v42
  v_exp_f32 v43, v43
  v_pk_add_f32 v[36:37], v[36:37], v[56:57]
  v_pk_add_f32 v[38:39], v[38:39], v[56:57]
  v_pk_add_f32 v[40:41], v[40:41], v[56:57]
  v_pk_add_f32 v[42:43], v[42:43], v[56:57]
  v_rcp_f32 v36, v36
  v_rcp_f32 v37, v37
  v_rcp_f32 v38, v38
  v_rcp_f32 v39, v39
  v_rcp_f32 v40, v40
  v_rcp_f32 v41, v41
  v_rcp_f32 v42, v42
  v_rcp_f32 v43, v43
  v_pk_mul_f32 v[64:65], v[64:65], v[36:37]
  v_pk_mul_f32 v[66:67], v[66:67], v[38:39]
  v_pk_mul_f32 v[68:69], v[68:69], v[40:41]
  v_pk_mul_f32 v[70:71], v[70:71], v[42:43]
  v_cvt_pk_bf16_f32 v64, v64, v65
  v_cvt_pk_bf16_f32 v65, v66, v67
  v_cvt_pk_bf16_f32 v66, v68, v69
  v_cvt_pk_bf16_f32 v67, v70, v71
  v_pk_mul_f32 v[36:37], v[72:73], v[72:73]
  v_pk_mul_f32 v[38:39], v[74:75], v[74:75]
  v_pk_mul_f32 v[40:41], v[76:77], v[76:77]
  v_pk_mul_f32 v[42:43], v[78:79], v[78:79]
  v_pk_fma_f32 v[36:37], v[36:37], v[54:55], v[52:53]
  v_pk_fma_f32 v[38:39], v[38:39], v[54:55], v[52:53]
  v_pk_fma_f32 v[40:41], v[40:41], v[54:55], v[52:53]
  v_pk_fma_f32 v[42:43], v[42:43], v[54:55], v[52:53]
  v_pk_mul_f32 v[36:37], v[36:37], v[72:73]
  v_pk_mul_f32 v[38:39], v[38:39], v[74:75]
  v_pk_mul_f32 v[40:41], v[40:41], v[76:77]
  v_pk_mul_f32 v[42:43], v[42:43], v[78:79]
  v_exp_f32 v36, v36
  v_exp_f32 v37, v37
  v_exp_f32 v38, v38
  v_exp_f32 v39, v39
  v_exp_f32 v40, v40
  v_exp_f32 v41, v41
  v_exp_f32 v42, v42
  v_exp_f32 v43, v43
  v_pk_add_f32 v[36:37], v[36:37], v[56:57]
  v_pk_add_f32 v[38:39], v[38:39], v[56:57]
  v_pk_add_f32 v[40:41], v[40:41], v[56:57]
  v_pk_add_f32 v[42:43], v[42:43], v[56:57]
  v_rcp_f32 v36, v36
  v_rcp_f32 v37, v37
  v_rcp_f32 v38, v38
  v_rcp_f32 v39, v39
  v_rcp_f32 v40, v40
  v_rcp_f32 v41, v41
  v_rcp_f32 v42, v42
  v_rcp_f32 v43, v43
  v_pk_mul_f32 v[72:73], v[72:73], v[36:37]
  v_pk_mul_f32 v[74:75], v[74:75], v[38:39]
  v_pk_mul_f32 v[76:77], v[76:77], v[40:41]
  v_pk_mul_f32 v[78:79], v[78:79], v[42:43]
  v_cvt_pk_bf16_f32 v68, v72, v73
  v_cvt_pk_bf16_f32 v69, v74, v75
  v_cvt_pk_bf16_f32 v70, v76, v77
  v_cvt_pk_bf16_f32 v71, v78, v79
  s_add_u32 s61, s100, 0
  buffer_store_dwordx4 v[64:67], v58, s[8:11], s61 offen sc1
  s_add_u32 s61, s100, 1024
  buffer_store_dwordx4 v[68:71], v58, s[8:11], s61 offen sc1
  v_pk_mul_f32 v[36:37], v[80:81], v[80:81]
  v_pk_mul_f32 v[38:39], v[82:83], v[82:83]
  v_pk_mul_f32 v[40:41], v[84:85], v[84:85]
  v_pk_mul_f32 v[42:43], v[86:87], v[86:87]
  v_pk_fma_f32 v[36:37], v[36:37], v[54:55], v[52:53]
  v_pk_fma_f32 v[38:39], v[38:39], v[54:55], v[52:53]
  v_pk_fma_f32 v[40:41], v[40:41], v[54:55], v[52:53]
  v_pk_fma_f32 v[42:43], v[42:43], v[54:55], v[52:53]
  v_pk_mul_f32 v[36:37], v[36:37], v[80:81]
  v_pk_mul_f32 v[38:39], v[38:39], v[82:83]
  v_pk_mul_f32 v[40:41], v[40:41], v[84:85]
  v_pk_mul_f32 v[42:43], v[42:43], v[86:87]
  v_exp_f32 v36, v36
  v_exp_f32 v37, v37
  v_exp_f32 v38, v38
  v_exp_f32 v39, v39
  v_exp_f32 v40, v40
  v_exp_f32 v41, v41
  v_exp_f32 v42, v42
  v_exp_f32 v43, v43
  v_pk_add_f32 v[36:37], v[36:37], v[56:57]
  v_pk_add_f32 v[38:39], v[38:39], v[56:57]
  v_pk_add_f32 v[40:41], v[40:41], v[56:57]
  v_pk_add_f32 v[42:43], v[42:43], v[56:57]
  v_rcp_f32 v36, v36
  v_rcp_f32 v37, v37
  v_rcp_f32 v38, v38
  v_rcp_f32 v39, v39
  v_rcp_f32 v40, v40
  v_rcp_f32 v41, v41
  v_rcp_f32 v42, v42
  v_rcp_f32 v43, v43
  v_pk_mul_f32 v[80:81], v[80:81], v[36:37]
  v_pk_mul_f32 v[82:83], v[82:83], v[38:39]
  v_pk_mul_f32 v[84:85], v[84:85], v[40:41]
  v_pk_mul_f32 v[86:87], v[86:87], v[42:43]
  v_cvt_pk_bf16_f32 v80, v80, v81
  v_cvt_pk_bf16_f32 v81, v82, v83
  v_cvt_pk_bf16_f32 v82, v84, v85
  v_cvt_pk_bf16_f32 v83, v86, v87
  v_pk_mul_f32 v[36:37], v[88:89], v[88:89]
  v_pk_mul_f32 v[38:39], v[90:91], v[90:91]
  v_pk_mul_f32 v[40:41], v[92:93], v[92:93]
  v_pk_mul_f32 v[42:43], v[94:95], v[94:95]
  v_pk_fma_f32 v[36:37], v[36:37], v[54:55], v[52:53]
  v_pk_fma_f32 v[38:39], v[38:39], v[54:55], v[52:53]
  v_pk_fma_f32 v[40:41], v[40:41], v[54:55], v[52:53]
  v_pk_fma_f32 v[42:43], v[42:43], v[54:55], v[52:53]
  v_pk_mul_f32 v[36:37], v[36:37], v[88:89]
  v_pk_mul_f32 v[38:39], v[38:39], v[90:91]
  v_pk_mul_f32 v[40:41], v[40:41], v[92:93]
  v_pk_mul_f32 v[42:43], v[42:43], v[94:95]
  v_exp_f32 v36, v36
  v_exp_f32 v37, v37
  v_exp_f32 v38, v38
  v_exp_f32 v39, v39
  v_exp_f32 v40, v40
  v_exp_f32 v41, v41
  v_exp_f32 v42, v42
  v_exp_f32 v43, v43
  v_pk_add_f32 v[36:37], v[36:37], v[56:57]
  v_pk_add_f32 v[38:39], v[38:39], v[56:57]
  v_pk_add_f32 v[40:41], v[40:41], v[56:57]
  v_pk_add_f32 v[42:43], v[42:43], v[56:57]
  v_rcp_f32 v36, v36
  v_rcp_f32 v37, v37
  v_rcp_f32 v38, v38
  v_rcp_f32 v39, v39
  v_rcp_f32 v40, v40
  v_rcp_f32 v41, v41
  v_rcp_f32 v42, v42
  v_rcp_f32 v43, v43
  v_pk_mul_f32 v[88:89], v[88:89], v[36:37]
  v_pk_mul_f32 v[90:91], v[90:91], v[38:39]
  v_pk_mul_f32 v[92:93], v[92:93], v[40:41]
  v_pk_mul_f32 v[94:95], v[94:95], v[42:43]
  v_cvt_pk_bf16_f32 v84, v88, v89
  v_cvt_pk_bf16_f32 v85, v90, v91
  v_cvt_pk_bf16_f32 v86, v92, v93
  v_cvt_pk_bf16_f32 v87, v94, v95
  s_add_u32 s61, s100, 110592
  buffer_store_dwordx4 v[80:83], v58, s[8:11], s61 offen sc1
  s_add_u32 s61, s100, 111616
  buffer_store_dwordx4 v[84:87], v58, s[8:11], s61 offen sc1
  s_branch L_Bpost
L_BnoF:
  s_lshr_b32 s60, s2, 3
  s_and_b32 s61, s2, 1
  s_sub_u32 s62, s46, 4
  s_mul_i32 s63, s60, 54
  s_mul_i32 s68, s62, 14
  s_add_u32 s63, s63, s68
  s_mul_i32 s68, s61, 640
  s_mov_b32 s16, s36
  s_and_b32 s17, s37, 0xffff
  s_mov_b32 s18, 0x21c000
  s_mov_b32 s19, 0x00020000
  v_lshrrev_b32 v60, 3, v1
  v_and_b32 v61, 7, v1
  v_min_u32 v61, 5, v61
  v_add_u32 v60, s63, v60
  v_mul_u32_u24 v60, 1280, v60
  v_lshl_add_u32 v60, v61, 7, v60
  buffer_load_dword v159, v60, s[16:19], s68 offen
  s_add_u32 s63, s63, 8
  s_mov_b32 s16, s36
  s_and_b32 s17, s37, 0xffff
  s_mov_b32 s18, 0x21c000
  s_mov_b32 s19, 0x00020000
  v_lshrrev_b32 v60, 3, v1
  v_and_b32 v61, 7, v1
  v_min_u32 v61, 5, v61
  v_add_u32 v60, s63, v60
  v_mul_u32_u24 v60, 1280, v60
  v_lshl_add_u32 v60, v61, 7, v60
  buffer_load_dword v159, v60, s[16:19], s68 offen
  s_mul_i32 s63, s60, 20
  s_mul_i32 s62, s62, 5
  s_add_u32 s63, s63, s62
  s_mov_b32 s16, s28
  s_and_b32 s17, s29, 0xffff
  s_mov_b32 s18, 0xc8000
  s_mov_b32 s19, 0x00020000
  v_lshrrev_b32 v60, 3, v1
  v_and_b32 v61, 7, v1
  v_min_u32 v61, 5, v61
  v_add_u32 v60, s63, v60
  v_mul_u32_u24 v60, 1280, v60
  v_lshl_add_u32 v60, v61, 7, v60
  buffer_load_dword v159, v60, s[16:19], s68 offen
L_Bpost:
  s_mul_i32 s99, s76, 15360
  s_add_u32 s99, s99, 81920
  v_bfe_u32 v141, v1, 2, 2
  v_lshl_add_u32 v141, v2, 2, v141
  v_mul_u32_u24 v141, 192, v141
  v_bfe_u32 v142, v1, 4, 1
  v_lshl_add_u32 v141, v142, 5, v141
  v_and_b32 v142, 3, v1
  v_lshl_add_u32 v141, v142, 3, v141
  v_add_u32 v144, s99, v141
  v_lshlrev_b32 v145, 4, v1
  v_mov_b32 v160, 0
  v_mov_b32 v161, 0
  v_mov_b32 v162, 0
  v_mov_b32 v163, 0
  v_mov_b32 v164, 0
  v_mov_b32 v165, 0
  v_mov_b32 v166, 0
  v_mov_b32 v167, 0
  v_mov_b32 v168, 0
  v_mov_b32 v169, 0
  v_mov_b32 v170, 0
  v_mov_b32 v171, 0
  v_mov_b32 v172, 0
  v_mov_b32 v173, 0
  v_mov_b32 v174, 0
  v_mov_b32 v175, 0
  v_mov_b32 v176, 0
  v_mov_b32 v177, 0
  v_mov_b32 v178, 0
  v_mov_b32 v179, 0
  v_mov_b32 v180, 0
  v_mov_b32 v181, 0
  v_mov_b32 v182, 0
  v_mov_b32 v183, 0
  v_mov_b32 v184, 0
  v_mov_b32 v185, 0
  v_mov_b32 v186, 0
  v_mov_b32 v187, 0
  v_mov_b32 v188, 0
  v_mov_b32 v189, 0
  v_mov_b32 v190, 0
  v_mov_b32 v191, 0
  v_mov_b32 v192, 0
  v_mov_b32 v193, 0
  v_mov_b32 v194, 0
  v_mov_b32 v195, 0
  v_mov_b32 v196, 0
  v_mov_b32 v197, 0
  v_mov_b32 v198, 0
  v_mov_b32 v199, 0
  v_mov_b32 v200, 0
  v_mov_b32 v201, 0
  v_mov_b32 v202, 0
  v_mov_b32 v203, 0
  v_mov_b32 v204, 0
  v_mov_b32 v205, 0
  v_mov_b32 v206, 0
  v_mov_b32 v207, 0
  v_mov_b32 v208, 0
  v_mov_b32 v209, 0
  v_mov_b32 v210, 0
  v_mov_b32 v211, 0
  v_mov_b32 v212, 0
  v_mov_b32 v213, 0
  v_mov_b32 v214, 0
  v_mov_b32 v215, 0
  v_mov_b32 v216, 0
  v_mov_b32 v217, 0
  v_mov_b32 v218, 0
  v_mov_b32 v219, 0
  v_mov_b32 v220, 0
  v_mov_b32 v221, 0
  v_mov_b32 v222, 0
  v_mov_b32 v223, 0
  v_mov_b32 v224, 0
  v_mov_b32 v225, 0
  v_mov_b32 v226, 0
  v_mov_b32 v227, 0
  v_mov_b32 v228, 0
  v_mov_b32 v229, 0
  v_mov_b32 v230, 0
  v_mov_b32 v231, 0
  v_mov_b32 v232, 0
  v_mov_b32 v233, 0
  v_mov_b32 v234, 0
  v_mov_b32 v235, 0
  v_mov_b32 v236, 0
  v_mov_b32 v237, 0
  v_mov_b32 v238, 0
  v_mov_b32 v239, 0
  v_mov_b32 v240, 0
  v_mov_b32 v241, 0
  v_mov_b32 v242, 0
  v_mov_b32 v243, 0
  v_mov_b32 v244, 0
  v_mov_b32 v245, 0
  v_mov_b32 v246, 0
  v_mov_b32 v247, 0
  v_mov_b32 v248, 0
  v_mov_b32 v249, 0
  v_mov_b32 v250, 0
  v_mov_b32 v251, 0
  v_mov_b32 v252, 0
  v_mov_b32 v253, 0
  v_mov_b32 v254, 0
  v_mov_b32 v255, 0
  s_waitcnt vmcnt(0)
  v_mov_b32 v52, 161820
  v_mov_b32 v53, 1
  s_mov_b64 exec, 1
  ds_add_rtn_u32 v54, v52, v53
  s_waitcnt lgkmcnt(0)
  v_readfirstlane_b32 s60, v54
  s_nop 3
  s_cmp_eq_u32 s60, 3
  s_cbranch_scc0 L_hflag_skipB
  s_lshl_b32 s60, s47, 3
  s_add_u32 s60, s60, s48
  s_lshl_b32 s60, s60, 7
  s_add_u32 s60, s60, 0
  v_mov_b32 v52, s50
  v_mov_b32 v53, 0
  v_mov_b32 v54, 0
  buffer_store_dwordx2 v[52:53], v54, s[8:11], s60 offen sc1
L_hflag_skipB:
  s_mov_b64 exec, -1
  s_lshr_b32 s60, s76, 1
  s_and_b32 s61, s76, 1
  s_lshl_b32 s62, s60, 5
  s_add_u32 s62, s62, s49
  v_add_u32 v146, s62, v3
  v_mul_u32_u24 v146, 1280, v146
  v_lshl_add_u32 v146, v2, 3, v146
  s_mul_i32 s62, s48, 160
  s_lshl_b32 s70, s61, 6
  s_add_u32 s70, s70, s62
  s_lshl_b32 s71, s61, 4
  s_add_u32 s71, s71, s62
  s_add_u32 s71, s71, 128
  v_lshlrev_b32 v147, 3, v2
  v_add_u32 v148, s70, v147
  v_add_u32 v149, s71, v147
  buffer_load_dwordx2 v[104:105], v146, s[4:7], s70 offen offset:0
  global_load_dwordx2 v[114:115], v148, s[38:39] offset:0
  buffer_load_dwordx2 v[106:107], v146, s[4:7], s70 offen offset:16
  global_load_dwordx2 v[116:117], v148, s[38:39] offset:16
  buffer_load_dwordx2 v[108:109], v146, s[4:7], s70 offen offset:32
  global_load_dwordx2 v[118:119], v148, s[38:39] offset:32
  buffer_load_dwordx2 v[110:111], v146, s[4:7], s70 offen offset:48
  global_load_dwordx2 v[120:121], v148, s[38:39] offset:48
  buffer_load_dwordx2 v[112:113], v146, s[4:7], s71 offen
  global_load_dwordx2 v[122:123], v149, s[38:39]
  s_waitcnt vmcnt(0)
  v_lshlrev_b32 v80, 16, v104
  v_and_b32 v81, 0xffff0000, v104
  v_lshlrev_b32 v104, 16, v114
  v_and_b32 v114, 0xffff0000, v114
  v_add_f32 v80, v80, v104
  v_add_f32 v81, v81, v114
  v_lshlrev_b32 v82, 16, v105
  v_and_b32 v83, 0xffff0000, v105
  v_lshlrev_b32 v105, 16, v115
  v_and_b32 v115, 0xffff0000, v115
  v_add_f32 v82, v82, v105
  v_add_f32 v83, v83, v115
  v_lshlrev_b32 v84, 16, v106
  v_and_b32 v85, 0xffff0000, v106
  v_lshlrev_b32 v106, 16, v116
  v_and_b32 v116, 0xffff0000, v116
  v_add_f32 v84, v84, v106
  v_add_f32 v85, v85, v116
  v_lshlrev_b32 v86, 16, v107
  v_and_b32 v87, 0xffff0000, v107
  v_lshlrev_b32 v107, 16, v117
  v_and_b32 v117, 0xffff0000, v117
  v_add_f32 v86, v86, v107
  v_add_f32 v87, v87, v117
  v_lshlrev_b32 v88, 16, v108
  v_and_b32 v89, 0xffff0000, v108
  v_lshlrev_b32 v108, 16, v118
  v_and_b32 v118, 0xffff0000, v118
  v_add_f32 v88, v88, v108
  v_add_f32 v89, v89, v118
  v_lshlrev_b32 v90, 16, v109
  v_and_b32 v91, 0xffff0000, v109
  v_lshlrev_b32 v109, 16, v119
  v_and_b32 v119, 0xffff0000, v119
  v_add_f32 v90, v90, v109
  v_add_f32 v91, v91, v119
  v_lshlrev_b32 v92, 16, v110
  v_and_b32 v93, 0xffff0000, v110
  v_lshlrev_b32 v110, 16, v120
  v_and_b32 v120, 0xffff0000, v120
  v_add_f32 v92, v92, v110
  v_add_f32 v93, v93, v120
  v_lshlrev_b32 v94, 16, v111
  v_and_b32 v95, 0xffff0000, v111
  v_lshlrev_b32 v111, 16, v121
  v_and_b32 v121, 0xffff0000, v121
  v_add_f32 v94, v94, v111
  v_add_f32 v95, v95, v121
  v_lshlrev_b32 v96, 16, v112
  v_and_b32 v97, 0xffff0000, v112
  v_lshlrev_b32 v112, 16, v122
  v_and_b32 v122, 0xffff0000, v122
  v_add_f32 v96, v96, v112
  v_add_f32 v97, v97, v122
  v_lshlrev_b32 v98, 16, v113
  v_and_b32 v99, 0xffff0000, v113
  v_lshlrev_b32 v113, 16, v123
  v_and_b32 v123, 0xffff0000, v123
  v_add_f32 v98, v98, v113
  v_add_f32 v99, v99, v123
  s_cmp_lg_u32 s76, 0
  s_cbranch_scc1 L_ri1X
  v_mov_b32 v160, v80
  v_mov_b32 v161, v81
  v_mov_b32 v162, v82
  v_mov_b32 v163, v83
  v_mov_b32 v164, v84
  v_mov_b32 v165, v85
  v_mov_b32 v166, v86
  v_mov_b32 v167, v87
  v_mov_b32 v168, v88
  v_mov_b32 v169, v89
  v_mov_b32 v170, v90
  v_mov_b32 v171, v91
  v_mov_b32 v172, v92
  v_mov_b32 v173, v93
  v_mov_b32 v174, v94
  v_mov_b32 v175, v95
  v_mov_b32 v224, v96
  v_mov_b32 v225, v97
  v_mov_b32 v226, v98
  v_mov_b32 v227, v99
  s_branch L_ri_doneX
L_ri1X:
  s_cmp_lg_u32 s76, 1
  s_cbranch_scc1 L_ri2X
  v_mov_b32 v192, v80
  v_mov_b32 v193, v81
  v_mov_b32 v194, v82
  v_mov_b32 v195, v83
  v_mov_b32 v196, v84
  v_mov_b32 v197, v85
  v_mov_b32 v198, v86
  v_mov_b32 v199, v87
  v_mov_b32 v200, v88
  v_mov_b32 v201, v89
  v_mov_b32 v202, v90
  v_mov_b32 v203, v91
  v_mov_b32 v204, v92
  v_mov_b32 v205, v93
  v_mov_b32 v206, v94
  v_mov_b32 v207, v95
  v_mov_b32 v228, v96
  v_mov_b32 v229, v97
  v_mov_b32 v230, v98
  v_mov_b32 v231, v99
  s_branch L_ri_doneX
L_ri2X:
  s_cmp_lg_u32 s76, 2
  s_cbranch_scc1 L_ri3X
  v_mov_b32 v176, v80
  v_mov_b32 v177, v81
  v_mov_b32 v178, v82
  v_mov_b32 v179, v83
  v_mov_b32 v180, v84
  v_mov_b32 v181, v85
  v_mov_b32 v182, v86
  v_mov_b32 v183, v87
  v_mov_b32 v184, v88
  v_mov_b32 v185, v89
  v_mov_b32 v186, v90
  v_mov_b32 v187, v91
  v_mov_b32 v188, v92
  v_mov_b32 v189, v93
  v_mov_b32 v190, v94
  v_mov_b32 v191, v95
  v_mov_b32 v240, v96
  v_mov_b32 v241, v97
  v_mov_b32 v242, v98
  v_mov_b32 v243, v99
  s_branch L_ri_doneX
L_ri3X:
  v_mov_b32 v208, v80
  v_mov_b32 v209, v81
  v_mov_b32 v210, v82
  v_mov_b32 v211, v83
  v_mov_b32 v212, v84
  v_mov_b32 v213, v85
  v_mov_b32 v214, v86
  v_mov_b32 v215, v87
  v_mov_b32 v216, v88
  v_mov_b32 v217, v89
  v_mov_b32 v218, v90
  v_mov_b32 v219, v91
  v_mov_b32 v220, v92
  v_mov_b32 v221, v93
  v_mov_b32 v222, v94
  v_mov_b32 v223, v95
  v_mov_b32 v244, v96
  v_mov_b32 v245, v97
  v_mov_b32 v246, v98
  v_mov_b32 v247, v99
L_ri_doneX:
  v_mov_b32 v10, v144
  v_mov_b32 v12, v145
  v_mov_b32 v13, v146
  v_mov_b32 v14, v147
  s_setprio 0
  s_branch L_phase2B
L_jobA:
  s_waitcnt vmcnt(2)
  v_mov_b32 v96, 0
  v_mov_b32 v97, 0
  v_mov_b32 v98, 0
  v_mov_b32 v99, 0
  v_mov_b32 v100, 0
  v_mov_b32 v101, 0
  v_mov_b32 v102, 0
  v_mov_b32 v103, 0
  v_mov_b32 v104, 0
  v_mov_b32 v105, 0
  v_mov_b32 v106, 0
  v_mov_b32 v107, 0
  v_mov_b32 v108, 0
  v_mov_b32 v109, 0
  v_mov_b32 v110, 0
  v_mov_b32 v111, 0
  v_mov_b32 v112, 0
  v_mov_b32 v113, 0
  v_mov_b32 v114, 0
  v_mov_b32 v115, 0
  v_mov_b32 v116, 0
  v_mov_b32 v117, 0
  v_mov_b32 v118, 0
  v_mov_b32 v119, 0
  v_mov_b32 v120, 0
  v_mov_b32 v121, 0
  v_mov_b32 v122, 0
  v_mov_b32 v123, 0
  v_mov_b32 v124, 0
  v_mov_b32 v125, 0
  v_mov_b32 v126, 0
  v_mov_b32 v127, 0
  s_barrier
  ds_read_b128 v[24:27], v10 offset:0
  ds_read_b128 v[28:31], v10 offset:40960
  ds_read_b64_tr_b16 v[20:21], v9 offset:0
  ds_read_b64_tr_b16 v[22:23], v9 offset:768
  ds_read_b128 v[36:39], v11 offset:0
  ds_read_b128 v[40:43], v11 offset:40960
  ds_read_b64_tr_b16 v[32:33], v9 offset:3072
  ds_read_b64_tr_b16 v[34:35], v9 offset:3840
  ds_read_b128 v[48:51], v12 offset:0
  ds_read_b128 v[52:55], v12 offset:40960
  ds_read_b64_tr_b16 v[44:45], v9 offset:6144
  ds_read_b64_tr_b16 v[46:47], v9 offset:6912
  s_waitcnt lgkmcnt(8)
  v_mfma_f32_32x32x16_bf16 v[96:111], v[20:23], v[24:27], v[96:111]
  v_mov_b32 v128, 0
  v_mov_b32 v129, 0
  v_mfma_f32_32x32x16_bf16 v[112:127], v[20:23], v[28:31], v[112:127]
  v_mov_b32 v130, 0
  v_mov_b32 v131, 0
  ds_read_b128 v[24:27], v13 offset:0
  ds_read_b128 v[28:31], v13 offset:40960
  ds_read_b64_tr_b16 v[20:21], v9 offset:9216
  ds_read_b64_tr_b16 v[22:23], v9 offset:9984
  s_waitcnt lgkmcnt(8)
  v_mfma_f32_32x32x16_bf16 v[96:111], v[32:35], v[36:39], v[96:111]
  v_mov_b32 v132, 0
  v_mov_b32 v133, 0
  v_mfma_f32_32x32x16_bf16 v[112:127], v[32:35], v[40:43], v[112:127]
  v_mov_b32 v134, 0
  v_mov_b32 v135, 0
  s_waitcnt lgkmcnt(0)
  s_barrier
  ds_read_b128 v[36:39], v14 offset:0
  ds_read_b128 v[40:43], v14 offset:40960
  ds_read_b64_tr_b16 v[32:33], v9 offset:12288
  ds_read_b64_tr_b16 v[34:35], v9 offset:13056
  v_mfma_f32_32x32x16_bf16 v[96:111], v[44:47], v[48:51], v[96:111]
  v_mov_b32 v136, 0
  v_mov_b32 v137, 0
  v_mfma_f32_32x32x16_bf16 v[112:127], v[44:47], v[52:55], v[112:127]
  v_mov_b32 v138, 0
  v_mov_b32 v139, 0
  ds_read_b128 v[48:51], v15 offset:0
  ds_read_b128 v[52:55], v15 offset:40960
  ds_read_b64_tr_b16 v[44:45], v9 offset:15360
  ds_read_b64_tr_b16 v[46:47], v9 offset:16128
  s_waitcnt lgkmcnt(8)
  v_mfma_f32_32x32x16_bf16 v[96:111], v[20:23], v[24:27], v[96:111]
  v_mov_b32 v140, 0
  v_mov_b32 v141, 0
  v_mfma_f32_32x32x16_bf16 v[112:127], v[20:23], v[28:31], v[112:127]
  v_mov_b32 v142, 0
  v_mov_b32 v143, 0
  ds_read_b128 v[24:27], v16 offset:0
  ds_read_b128 v[28:31], v16 offset:40960
  ds_read_b64_tr_b16 v[20:21], v9 offset:18432
  ds_read_b64_tr_b16 v[22:23], v9 offset:19200
  s_waitcnt lgkmcnt(8)
  v_mfma_f32_32x32x16_bf16 v[96:111], v[32:35], v[36:39], v[96:111]
  v_mov_b32 v144, 0
  v_mov_b32 v145, 0
  v_mfma_f32_32x32x16_bf16 v[112:127], v[32:35], v[40:43], v[112:127]
  v_mov_b32 v146, 0
  v_mov_b32 v147, 0
  ds_read_b128 v[36:39], v17 offset:0
  ds_read_b128 v[40:43], v17 offset:40960
  ds_read_b64_tr_b16 v[32:33], v9 offset:21504
  ds_read_b64_tr_b16 v[34:35], v9 offset:22272
  s_waitcnt lgkmcnt(8)
  v_mfma_f32_32x32x16_bf16 v[96:111], v[44:47], v[48:51], v[96:111]
  v_mov_b32 v148, 0
  v_mov_b32 v149, 0
  v_mfma_f32_32x32x16_bf16 v[112:127], v[44:47], v[52:55], v[112:127]
  v_mov_b32 v150, 0
  v_mov_b32 v151, 0
  s_waitcnt lgkmcnt(0)
  s_barrier
  ds_read_b128 v[48:51], v10 offset:256
  ds_read_b128 v[52:55], v10 offset:41216
  ds_read_b64_tr_b16 v[44:45], v9 offset:24576
  ds_read_b64_tr_b16 v[46:47], v9 offset:25344
  v_mfma_f32_32x32x16_bf16 v[96:111], v[20:23], v[24:27], v[96:111]
  v_mov_b32 v152, 0
  v_mov_b32 v153, 0
  v_mfma_f32_32x32x16_bf16 v[112:127], v[20:23], v[28:31], v[112:127]
  v_mov_b32 v154, 0
  v_mov_b32 v155, 0
  ds_read_b128 v[24:27], v11 offset:256
  ds_read_b128 v[28:31], v11 offset:41216
  ds_read_b64_tr_b16 v[20:21], v9 offset:27648
  ds_read_b64_tr_b16 v[22:23], v9 offset:28416
  s_waitcnt lgkmcnt(8)
  v_mfma_f32_32x32x16_bf16 v[96:111], v[32:35], v[36:39], v[96:111]
  v_mov_b32 v156, 0
  v_mov_b32 v157, 0
  v_mfma_f32_32x32x16_bf16 v[112:127], v[32:35], v[40:43], v[112:127]
  v_mov_b32 v158, 0
  v_mov_b32 v159, 0
  ds_read_b128 v[36:39], v12 offset:256
  ds_read_b128 v[40:43], v12 offset:41216
  ds_read_b64_tr_b16 v[32:33], v9 offset:30720
  ds_read_b64_tr_b16 v[34:35], v9 offset:31488
  s_waitcnt lgkmcnt(8)
  v_mfma_f32_32x32x16_bf16 v[96:111], v[44:47], v[48:51], v[96:111]
  v_mov_b32 v160, 0
  v_mov_b32 v161, 0
  v_mfma_f32_32x32x16_bf16 v[112:127], v[44:47], v[52:55], v[112:127]
  v_mov_b32 v162, 0
  v_mov_b32 v163, 0
  ds_read_b128 v[48:51], v13 offset:256
  ds_read_b128 v[52:55], v13 offset:41216
  ds_read_b64_tr_b16 v[44:45], v9 offset:33792
  ds_read_b64_tr_b16 v[46:47], v9 offset:34560
  s_waitcnt lgkmcnt(8)
  v_mfma_f32_32x32x16_bf16 v[96:111], v[20:23], v[24:27], v[96:111]
  v_mov_b32 v164, 0
  v_mov_b32 v165, 0
  v_mfma_f32_32x32x16_bf16 v[112:127], v[20:23], v[28:31], v[112:127]
  v_mov_b32 v166, 0
  v_mov_b32 v167, 0
  s_waitcnt lgkmcnt(0)
  s_barrier
  ds_read_b128 v[24:27], v14 offset:256
  ds_read_b128 v[28:31], v14 offset:41216
  ds_read_b64_tr_b16 v[20:21], v9 offset:36864
  ds_read_b64_tr_b16 v[22:23], v9 offset:37632
  v_mfma_f32_32x32x16_bf16 v[96:111], v[32:35], v[36:39], v[96:111]
  v_mov_b32 v168, 0
  v_mov_b32 v169, 0
  v_mfma_f32_32x32x16_bf16 v[112:127], v[32:35], v[40:43], v[112:127]
  v_mov_b32 v170, 0
  v_mov_b32 v171, 0
  ds_read_b128 v[36:39], v15 offset:256
  ds_read_b128 v[40:43], v15 offset:41216
  ds_read_b64_tr_b16 v[32:33], v9 offset:39936
  ds_read_b64_tr_b16 v[34:35], v9 offset:40704
  s_waitcnt lgkmcnt(8)
  v_mfma_f32_32x32x16_bf16 v[96:111], v[44:47], v[48:51], v[96:111]
  v_mov_b32 v172, 0
  v_mov_b32 v173, 0
  v_mfma_f32_32x32x16_bf16 v[112:127], v[44:47], v[52:55], v[112:127]
  v_mov_b32 v174, 0
  v_mov_b32 v175, 0
  ds_read_b128 v[48:51], v16 offset:256
  ds_read_b128 v[52:55], v16 offset:41216
  ds_read_b64_tr_b16 v[44:45], v9 offset:43008
  ds_read_b64_tr_b16 v[46:47], v9 offset:43776
  s_waitcnt lgkmcnt(8)
  v_mfma_f32_32x32x16_bf16 v[96:111], v[20:23], v[24:27], v[96:111]
  v_mov_b32 v176, 0
  v_mov_b32 v177, 0
  v_mfma_f32_32x32x16_bf16 v[112:127], v[20:23], v[28:31], v[112:127]
  v_mov_b32 v178, 0
  v_mov_b32 v179, 0
  ds_read_b128 v[24:27], v17 offset:256
  ds_read_b128 v[28:31], v17 offset:41216
  ds_read_b64_tr_b16 v[20:21], v9 offset:46080
  ds_read_b64_tr_b16 v[22:23], v9 offset:46848
  s_waitcnt lgkmcnt(8)
  v_mfma_f32_32x32x16_bf16 v[96:111], v[32:35], v[36:39], v[96:111]
  v_mov_b32 v180, 0
  v_mov_b32 v181, 0
  v_mfma_f32_32x32x16_bf16 v[112:127], v[32:35], v[40:43], v[112:127]
  v_mov_b32 v182, 0
  v_mov_b32 v183, 0
  s_waitcnt lgkmcnt(0)
  s_barrier
  ds_read_b128 v[36:39], v10 offset:512
  ds_read_b128 v[40:43], v10 offset:41472
  ds_read_b64_tr_b16 v[32:33], v9 offset:0
  ds_read_b64_tr_b16 v[34:35], v9 offset:768
  v_mfma_f32_32x32x16_bf16 v[96:111], v[44:47], v[48:51], v[96:111]
  v_mov_b32 v184, 0
  v_mov_b32 v185, 0
  v_mfma_f32_32x32x16_bf16 v[112:127], v[44:47], v[52:55], v[112:127]
  v_mov_b32 v186, 0
  v_mov_b32 v187, 0
  ds_read_b128 v[48:51], v11 offset:512
  ds_read_b128 v[52:55], v11 offset:41472
  ds_read_b64_tr_b16 v[44:45], v9 offset:3072
  ds_read_b64_tr_b16 v[46:47], v9 offset:3840
  s_waitcnt lgkmcnt(8)
  v_mfma_f32_32x32x16_bf16 v[96:111], v[20:23], v[24:27], v[96:111]
  v_mov_b32 v188, 0
  v_mov_b32 v189, 0
  v_mfma_f32_32x32x16_bf16 v[112:127], v[20:23], v[28:31], v[112:127]
  v_mov_b32 v190, 0
  v_mov_b32 v191, 0
  ds_read_b128 v[24:27], v12 offset:512
  ds_read_b128 v[28:31], v12 offset:41472
  ds_read_b64_tr_b16 v[20:21], v9 offset:6144
  ds_read_b64_tr_b16 v[22:23], v9 offset:6912
  s_waitcnt lgkmcnt(8)
  v_mfma_f32_32x32x16_bf16 v[96:111], v[32:35], v[36:39], v[96:111]
  v_mov_b32 v192, 0
  v_mov_b32 v193, 0
  v_mfma_f32_32x32x16_bf16 v[112:127], v[32:35], v[40:43], v[112:127]
  v_mov_b32 v194, 0
  v_mov_b32 v195, 0
  ds_read_b128 v[36:39], v13 offset:512
  ds_read_b128 v[40:43], v13 offset:41472
  ds_read_b64_tr_b16 v[32:33], v9 offset:9216
  ds_read_b64_tr_b16 v[34:35], v9 offset:9984
  s_waitcnt lgkmcnt(8)
  v_mfma_f32_32x32x16_bf16 v[96:111], v[44:47], v[48:51], v[96:111]
  v_mov_b32 v196, 0
  v_mov_b32 v197, 0
  v_mfma_f32_32x32x16_bf16 v[112:127], v[44:47], v[52:55], v[112:127]
  v_mov_b32 v198, 0
  v_mov_b32 v199, 0
  s_waitcnt lgkmcnt(0)
  s_barrier
  ds_read_b128 v[48:51], v14 offset:512
  ds_read_b128 v[52:55], v14 offset:41472
  ds_read_b64_tr_b16 v[44:45], v9 offset:12288
  ds_read_b64_tr_b16 v[46:47], v9 offset:13056
  v_mfma_f32_32x32x16_bf16 v[96:111], v[20:23], v[24:27], v[96:111]
  v_mov_b32 v200, 0
  v_mov_b32 v201, 0
  v_mfma_f32_32x32x16_bf16 v[112:127], v[20:23], v[28:31], v[112:127]
  v_mov_b32 v202, 0
  v_mov_b32 v203, 0
  ds_read_b128 v[24:27], v15 offset:512
  ds_read_b128 v[28:31], v15 offset:41472
  ds_read_b64_tr_b16 v[20:21], v9 offset:15360
  ds_read_b64_tr_b16 v[22:23], v9 offset:16128
  s_waitcnt lgkmcnt(8)
  v_mfma_f32_32x32x16_bf16 v[96:111], v[32:35], v[36:39], v[96:111]
  v_mov_b32 v204, 0
  v_mov_b32 v205, 0
  v_mfma_f32_32x32x16_bf16 v[112:127], v[32:35], v[40:43], v[112:127]
  v_mov_b32 v206, 0
  v_mov_b32 v207, 0
  ds_read_b128 v[36:39], v16 offset:512
  ds_read_b128 v[40:43], v16 offset:41472
  ds_read_b64_tr_b16 v[32:33], v9 offset:18432
  ds_read_b64_tr_b16 v[34:35], v9 offset:19200
  s_waitcnt lgkmcnt(8)
  v_mfma_f32_32x32x16_bf16 v[96:111], v[44:47], v[48:51], v[96:111]
  v_mov_b32 v208, 0
  v_mov_b32 v209, 0
  v_mfma_f32_32x32x16_bf16 v[112:127], v[44:47], v[52:55], v[112:127]
  v_mov_b32 v210, 0
  v_mov_b32 v211, 0
  ds_read_b128 v[48:51], v17 offset:512
  ds_read_b128 v[52:55], v17 offset:41472
  ds_read_b64_tr_b16 v[44:45], v9 offset:21504
  ds_read_b64_tr_b16 v[46:47], v9 offset:22272
  s_waitcnt lgkmcnt(8)
  v_mfma_f32_32x32x16_bf16 v[96:111], v[20:23], v[24:27], v[96:111]
  v_mov_b32 v212, 0
  v_mov_b32 v213, 0
  v_mfma_f32_32x32x16_bf16 v[112:127], v[20:23], v[28:31], v[112:127]
  v_mov_b32 v214, 0
  v_mov_b32 v215, 0
  s_waitcnt lgkmcnt(0)
  s_barrier
  ds_read_b128 v[24:27], v10 offset:768
  ds_read_b128 v[28:31], v10 offset:41728
  ds_read_b64_tr_b16 v[20:21], v9 offset:24576
  ds_read_b64_tr_b16 v[22:23], v9 offset:25344
  v_mfma_f32_32x32x16_bf16 v[96:111], v[32:35], v[36:39], v[96:111]
  v_mov_b32 v216, 0
  v_mov_b32 v217, 0
  v_mfma_f32_32x32x16_bf16 v[112:127], v[32:35], v[40:43], v[112:127]
  v_mov_b32 v218, 0
  v_mov_b32 v219, 0
  ds_read_b128 v[36:39], v11 offset:768
  ds_read_b128 v[40:43], v11 offset:41728
  ds_read_b64_tr_b16 v[32:33], v9 offset:27648
  ds_read_b64_tr_b16 v[34:35], v9 offset:28416
  s_waitcnt lgkmcnt(8)
  v_mfma_f32_32x32x16_bf16 v[96:111], v[44:47], v[48:51], v[96:111]
  v_mov_b32 v220, 0
  v_mov_b32 v221, 0
  v_mfma_f32_32x32x16_bf16 v[112:127], v[44:47], v[52:55], v[112:127]
  v_mov_b32 v222, 0
  v_mov_b32 v223, 0
  ds_read_b128 v[48:51], v12 offset:768
  ds_read_b128 v[52:55], v12 offset:41728
  ds_read_b64_tr_b16 v[44:45], v9 offset:30720
  ds_read_b64_tr_b16 v[46:47], v9 offset:31488
  s_waitcnt lgkmcnt(8)
  v_mfma_f32_32x32x16_bf16 v[96:111], v[20:23], v[24:27], v[96:111]
  v_mov_b32 v224, 0
  v_mov_b32 v225, 0
  v_mfma_f32_32x32x16_bf16 v[112:127], v[20:23], v[28:31], v[112:127]
  v_mov_b32 v226, 0
  v_mov_b32 v227, 0
  ds_read_b128 v[24:27], v13 offset:768
  ds_read_b128 v[28:31], v13 offset:41728
  ds_read_b64_tr_b16 v[20:21], v9 offset:33792
  ds_read_b64_tr_b16 v[22:23], v9 offset:34560
  s_waitcnt lgkmcnt(8)
  v_mfma_f32_32x32x16_bf16 v[96:111], v[32:35], v[36:39], v[96:111]
  v_mov_b32 v228, 0
  v_mov_b32 v229, 0
  v_mfma_f32_32x32x16_bf16 v[112:127], v[32:35], v[40:43], v[112:127]
  v_mov_b32 v230, 0
  v_mov_b32 v231, 0
  s_waitcnt lgkmcnt(0)
  s_barrier
  ds_read_b128 v[36:39], v14 offset:768
  ds_read_b128 v[40:43], v14 offset:41728
  ds_read_b64_tr_b16 v[32:33], v9 offset:36864
  ds_read_b64_tr_b16 v[34:35], v9 offset:37632
  v_mfma_f32_32x32x16_bf16 v[96:111], v[44:47], v[48:51], v[96:111]
  v_mov_b32 v232, 0
  v_mov_b32 v233, 0
  v_mfma_f32_32x32x16_bf16 v[112:127], v[44:47], v[52:55], v[112:127]
  v_mov_b32 v234, 0
  v_mov_b32 v235, 0
  ds_read_b128 v[48:51], v15 offset:768
  ds_read_b128 v[52:55], v15 offset:41728
  ds_read_b64_tr_b16 v[44:45], v9 offset:39936
  ds_read_b64_tr_b16 v[46:47], v9 offset:40704
  s_waitcnt lgkmcnt(8)
  v_mfma_f32_32x32x16_bf16 v[96:111], v[20:23], v[24:27], v[96:111]
  v_mov_b32 v236, 0
  v_mov_b32 v237, 0
  v_mfma_f32_32x32x16_bf16 v[112:127], v[20:23], v[28:31], v[112:127]
  v_mov_b32 v238, 0
  v_mov_b32 v239, 0
  ds_read_b128 v[24:27], v16 offset:768
  ds_read_b128 v[28:31], v16 offset:41728
  ds_read_b64_tr_b16 v[20:21], v9 offset:43008
  ds_read_b64_tr_b16 v[22:23], v9 offset:43776
  s_waitcnt lgkmcnt(8)
  v_mfma_f32_32x32x16_bf16 v[96:111], v[32:35], v[36:39], v[96:111]
  v_mov_b32 v240, 0
  v_mov_b32 v241, 0
  v_mfma_f32_32x32x16_bf16 v[112:127], v[32:35], v[40:43], v[112:127]
  v_mov_b32 v242, 0
  v_mov_b32 v243, 0
  ds_read_b128 v[36:39], v17 offset:768
  ds_read_b128 v[40:43], v17 offset:41728
  ds_read_b64_tr_b16 v[32:33], v9 offset:46080
  ds_read_b64_tr_b16 v[34:35], v9 offset:46848
  s_waitcnt lgkmcnt(8)
  v_mfma_f32_32x32x16_bf16 v[96:111], v[44:47], v[48:51], v[96:111]
  v_mov_b32 v244, 0
  v_mov_b32 v245, 0
  v_mfma_f32_32x32x16_bf16 v[112:127], v[44:47], v[52:55], v[112:127]
  v_mov_b32 v246, 0
  v_mov_b32 v247, 0
  s_waitcnt lgkmcnt(0)
  s_barrier
  ds_read_b128 v[48:51], v10 offset:1024
  ds_read_b128 v[52:55], v10 offset:41984
  ds_read_b64_tr_b16 v[44:45], v9 offset:0
  ds_read_b64_tr_b16 v[46:47], v9 offset:768
  v_mfma_f32_32x32x16_bf16 v[96:111], v[20:23], v[24:27], v[96:111]
  v_mov_b32 v248, 0
  v_mov_b32 v249, 0
  v_mfma_f32_32x32x16_bf16 v[112:127], v[20:23], v[28:31], v[112:127]
  v_mov_b32 v250, 0
  v_mov_b32 v251, 0
  ds_read_b128 v[24:27], v11 offset:1024
  ds_read_b128 v[28:31], v11 offset:41984
  ds_read_b64_tr_b16 v[20:21], v9 offset:3072
  ds_read_b64_tr_b16 v[22:23], v9 offset:3840
  s_waitcnt lgkmcnt(8)
  v_mfma_f32_32x32x16_bf16 v[96:111], v[32:35], v[36:39], v[96:111]
  v_mov_b32 v252, 0
  v_mov_b32 v253, 0
  v_mfma_f32_32x32x16_bf16 v[112:127], v[32:35], v[40:43], v[112:127]
  v_mov_b32 v254, 0
  v_mov_b32 v255, 0
  ds_read_b128 v[36:39], v12 offset:1024
  ds_read_b128 v[40:43], v12 offset:41984
  ds_read_b64_tr_b16 v[32:33], v9 offset:6144
  ds_read_b64_tr_b16 v[34:35], v9 offset:6912
  s_waitcnt lgkmcnt(8)
  v_mfma_f32_32x32x16_bf16 v[96:111], v[44:47], v[48:51], v[96:111]
  v_mfma_f32_32x32x16_bf16 v[112:127], v[44:47], v[52:55], v[112:127]
  ds_read_b128 v[48:51], v13 offset:1024
  ds_read_b128 v[52:55], v13 offset:41984
  ds_read_b64_tr_b16 v[44:45], v9 offset:9216
  ds_read_b64_tr_b16 v[46:47], v9 offset:9984
  s_waitcnt lgkmcnt(8)
  v_mfma_f32_32x32x16_bf16 v[96:111], v[20:23], v[24:27], v[96:111]
  v_mfma_f32_32x32x16_bf16 v[112:127], v[20:23], v[28:31], v[112:127]
  s_waitcnt lgkmcnt(0)
  s_barrier
  ds_read_b128 v[24:27], v14 offset:1024
  ds_read_b128 v[28:31], v14 offset:41984
  ds_read_b64_tr_b16 v[20:21], v9 offset:12288
  ds_read_b64_tr_b16 v[22:23], v9 offset:13056
  v_mfma_f32_32x32x16_bf16 v[96:111], v[32:35], v[36:39], v[96:111]
  v_mfma_f32_32x32x16_bf16 v[112:127], v[32:35], v[40:43], v[112:127]
  ds_read_b128 v[36:39], v15 offset:1024
  ds_read_b128 v[40:43], v15 offset:41984
  ds_read_b64_tr_b16 v[32:33], v9 offset:15360
  ds_read_b64_tr_b16 v[34:35], v9 offset:16128
  s_waitcnt lgkmcnt(8)
  v_mfma_f32_32x32x16_bf16 v[96:111], v[44:47], v[48:51], v[96:111]
  v_mfma_f32_32x32x16_bf16 v[112:127], v[44:47], v[52:55], v[112:127]
  ds_read_b128 v[48:51], v16 offset:1024
  ds_read_b128 v[52:55], v16 offset:41984
  ds_read_b64_tr_b16 v[44:45], v9 offset:18432
  ds_read_b64_tr_b16 v[46:47], v9 offset:19200
  s_waitcnt lgkmcnt(8)
  v_mfma_f32_32x32x16_bf16 v[96:111], v[20:23], v[24:27], v[96:111]
  v_mfma_f32_32x32x16_bf16 v[112:127], v[20:23], v[28:31], v[112:127]
  ds_read_b128 v[24:27], v17 offset:1024
  ds_read_b128 v[28:31], v17 offset:41984
  ds_read_b64_tr_b16 v[20:21], v9 offset:21504
  ds_read_b64_tr_b16 v[22:23], v9 offset:22272
  s_waitcnt lgkmcnt(8)
  v_mfma_f32_32x32x16_bf16 v[96:111], v[32:35], v[36:39], v[96:111]
  v_mfma_f32_32x32x16_bf16 v[112:127], v[32:35], v[40:43], v[112:127]
  s_waitcnt lgkmcnt(4)
  v_mfma_f32_32x32x16_bf16 v[96:111], v[44:47], v[48:51], v[96:111]
  v_mfma_f32_32x32x16_bf16 v[112:127], v[44:47], v[52:55], v[112:127]
  s_waitcnt lgkmcnt(0)
  v_mfma_f32_32x32x16_bf16 v[96:111], v[20:23], v[24:27], v[96:111]
  v_mfma_f32_32x32x16_bf16 v[112:127], v[20:23], v[28:31], v[112:127]
  s_barrier
  s_nop 15
  v_cmp_eq_u32 vcc, 0, v2
  s_mov_b64 s[62:63], vcc
  s_mul_i32 s60, s46, 3072
  s_add_u32 s60, s60, 149504
  v_lshlrev_b32 v60, 4, v1
  v_add_u32 v60, s60, v60
  v_lshlrev_b32 v61, 3, v1
  v_add_u32 v61, s60, v61
  v_mul_f32 v96, 0x3ea52b5c, v96
  v_mul_f32 v97, 0x3ea52b5c, v97
  v_mul_f32 v98, 0x3ea52b5c, v98
  v_mul_f32 v99, 0x3ea52b5c, v99
  v_mul_f32 v100, 0x3ea52b5c, v100
  v_mul_f32 v101, 0x3ea52b5c, v101
  v_mul_f32 v102, 0x3ea52b5c, v102
  v_mul_f32 v103, 0x3ea52b5c, v103
  v_mul_f32 v104, 0x3ea52b5c, v104
  v_mul_f32 v105, 0x3ea52b5c, v105
  v_mul_f32 v106, 0x3ea52b5c, v106
  v_mul_f32 v107, 0x3ea52b5c, v107
  v_mul_f32 v52, v96, v96
  v_fmac_f32 v52, v97, v97
  v_fmac_f32 v52, v98, v98
  v_fmac_f32 v52, v99, v99
  v_fmac_f32 v52, v100, v100
  v_fmac_f32 v52, v101, v101
  v_fmac_f32 v52, v102, v102
  v_fmac_f32 v52, v103, v103
  v_mul_f32 v53, v104, v104
  v_fmac_f32 v53, v105, v105
  v_fmac_f32 v53, v106, v106
  v_fmac_f32 v53, v107, v107
  v_cndmask_b32 v53, 0, v53, vcc
  v_add_f32 v52, v52, v53
  v_mov_b32 v53, v52
  s_nop 1
  v_permlane32_swap_b32 v52, v53
  s_nop 1
  v_add_f32 v52, v52, v53
  v_cvt_pk_bf16_f32 v96, v96, v97
  v_cvt_pk_bf16_f32 v97, v98, v99
  v_cvt_pk_bf16_f32 v98, v100, v101
  v_cvt_pk_bf16_f32 v99, v102, v103
  v_cvt_pk_bf16_f32 v100, v104, v105
  v_cvt_pk_bf16_f32 v101, v106, v107
  v_cndmask_b32 v100, v52, v100, vcc
  v_cndmask_b32 v101, 0, v101, vcc
  ds_write_b128 v60, v[96:99] offset:0
  ds_write_b64 v61, v[100:101] offset:1024
  v_mul_f32 v112, 0x3ea52b5c, v112
  v_mul_f32 v113, 0x3ea52b5c, v113
  v_mul_f32 v114, 0x3ea52b5c, v114
  v_mul_f32 v115, 0x3ea52b5c, v115
  v_mul_f32 v116, 0x3ea52b5c, v116
  v_mul_f32 v117, 0x3ea52b5c, v117
  v_mul_f32 v118, 0x3ea52b5c, v118
  v_mul_f32 v119, 0x3ea52b5c, v119
  v_mul_f32 v120, 0x3ea52b5c, v120
  v_mul_f32 v121, 0x3ea52b5c, v121
  v_mul_f32 v122, 0x3ea52b5c, v122
  v_mul_f32 v123, 0x3ea52b5c, v123
  v_mul_f32 v52, v112, v112
  v_fmac_f32 v52, v113, v113
  v_fmac_f32 v52, v114, v114
  v_fmac_f32 v52, v115, v115
  v_fmac_f32 v52, v116, v116
  v_fmac_f32 v52, v117, v117
  v_fmac_f32 v52, v118, v118
  v_fmac_f32 v52, v119, v119
  v_mul_f32 v53, v120, v120
  v_fmac_f32 v53, v121, v121
  v_fmac_f32 v53, v122, v122
  v_fmac_f32 v53, v123, v123
  v_cndmask_b32 v53, 0, v53, vcc
  v_add_f32 v52, v52, v53
  v_mov_b32 v53, v52
  s_nop 1
  v_permlane32_swap_b32 v52, v53
  s_nop 1
  v_add_f32 v52, v52, v53
  v_cvt_pk_bf16_f32 v112, v112, v113
  v_cvt_pk_bf16_f32 v113, v114, v115
  v_cvt_pk_bf16_f32 v114, v116, v117
  v_cvt_pk_bf16_f32 v115, v118, v119
  v_cvt_pk_bf16_f32 v116, v120, v121
  v_cvt_pk_bf16_f32 v117, v122, v123
  v_cndmask_b32 v116, v52, v116, vcc
  v_cndmask_b32 v117, 0, v117, vcc
  ds_write_b128 v60, v[112:115] offset:1536
  ds_write_b64 v61, v[116:117] offset:2560
  s_waitcnt lgkmcnt(0)
  s_lshl_b32 s60, s46, 2
  s_add_u32 s60, s60, 161792
  v_mov_b32 v52, s60
  v_mov_b32 v53, 1
  ds_write_b32 v52, v53
  s_setprio 1
  s_branch L_phase2A
L_phase2A:
  s_cmp_lg_u32 s46, 0
  s_cbranch_scc1 L_akv_wait
  s_and_b32 s61, s2, 7
  s_lshl_b32 s61, s61, 14
  s_add_u32 s61, s61, 11534336
  s_add_u32 s62, s61, 8192
  v_lshlrev_b32 v32, 7, v1
  s_mov_b32 s57, 0
KV_poll:
  buffer_load_dwordx2 v[34:35], v32, s[8:11], s61 offen sc1
  buffer_load_dwordx2 v[36:37], v32, s[8:11], s62 offen sc1
  s_waitcnt vmcnt(0)
  v_cmp_eq_u32 vcc, s50, v34
  v_cmp_eq_u32 s[74:75], s50, v36
  s_nop 3
  s_and_b64 vcc, vcc, s[74:75]
  s_cmp_eq_u64 vcc, -1
  s_cbranch_scc1 KV_ok
  s_add_u32 s57, s57, 1
  s_cmp_ge_u32 s57, 1000000
  s_cbranch_scc1 KV_to
  s_sleep 4
  s_branch KV_poll
KV_to:
KV_ok:
  s_nop 1
  v_max_f32_dpp v35, v35, v35 quad_perm:[1,0,3,2] row_mask:0xf bank_mask:0xf
  s_nop 1
  v_max_f32_dpp v35, v35, v35 quad_perm:[2,3,0,1] row_mask:0xf bank_mask:0xf
  s_nop 1
  v_max_f32_dpp v35, v35, v35 row_half_mirror row_mask:0xf bank_mask:0xf
  s_nop 1
  v_max_f32_dpp v35, v35, v35 row_mirror row_mask:0xf bank_mask:0xf
  s_nop 1
  v_mov_b32 v36, v35
  s_nop 1
  v_permlane16_swap_b32 v35, v36
  s_nop 1
  v_max_f32 v35, v35, v36
  v_mov_b32 v36, v35
  s_nop 1
  v_permlane32_swap_b32 v35, v36
  s_nop 1
  v_max_f32 v35, v35, v36
  s_nop 1
  v_readfirstlane_b32 s60, v35
  v_mov_b32 v36, 161808
  s_nop 1
  v_mov_b32 v35, s60
  ds_write_b32 v36, v35 offset:4
  v_mov_b32 v37, 1
  ds_write_b32 v36, v37
  s_lshr_b32 s60, s2, 3
  s_mul_i32 s60, s60, 7168
  s_add_u32 s60, s60, 65536
  v_lshlrev_b32 v32, 7, v1
  v_min_u32 v32, 7040, v32
  buffer_load_dword v42, v32, s[8:11], s60 offen sc1
L_akv_wait:
  v_mov_b32 v32, 161808
  s_mov_b32 s57, 0
KVR_spin:
  ds_read_b32 v34, v32
  s_waitcnt lgkmcnt(0)
  s_nop 0
  v_readfirstlane_b32 s60, v34
  s_nop 3
  s_cmp_lg_u32 s60, 0
  s_cbranch_scc1 KVR_ok
  s_add_u32 s57, s57, 1
  s_cmp_ge_u32 s57, 4000000
  s_cbranch_scc1 KVR_to
  s_sleep 3
  s_branch KVR_spin
KVR_to:
KVR_ok:
  s_mov_b32 s65, 16
  s_mul_i32 s66, s46, 57344
  s_cmp_lt_u32 s48, 6
  s_cbranch_scc1 L_ksplit_done
  s_mul_i32 s66, s46, 53760
  s_cmp_eq_u32 s46, 3
  s_cselect_b32 s65, 19, 15
L_ksplit_done:
  s_add_u32 s66, s66, 65536
  v_lshlrev_b32 v44, 4, v1
  v_lshlrev_b32 v45, 3, v1
  buffer_load_dwordx4 v[4:7], v44, s[8:11], s66 offen offset:0 sc1
  buffer_load_dwordx2 v[16:17], v45, s[8:11], s66 offen offset:3072 sc1
  buffer_load_dwordx4 v[8:11], v44, s[8:11], s66 offen offset:1024 sc1
  buffer_load_dwordx4 v[12:15], v44, s[8:11], s66 offen offset:2048 sc1
  s_add_u32 s66, s66, 3584
  v_mov_b32 v32, 161840
  v_mov_b32 v33, 1
  ds_write_b32 v32, v33
  v_mov_b32 v32, 161792
  s_mov_b32 s57, 0
QF_spin:
  ds_read_b128 v[34:37], v32
  s_waitcnt lgkmcnt(0)
  v_min_u32 v34, v34, v35
  v_min_u32 v36, v36, v37
  v_min_u32 v34, v34, v36
  s_nop 0
  v_readfirstlane_b32 s60, v34
  s_nop 3
  s_cmp_lg_u32 s60, 0
  s_cbranch_scc1 QF_ok
  s_add_u32 s57, s57, 1
  s_cmp_ge_u32 s57, 4000000
  s_cbranch_scc1 QF_to
  s_sleep 3
  s_branch QF_spin
QF_to:
QF_ok:
  v_mov_b32 v40, v1
  v_lshlrev_b32 v2, 3, v1
  v_lshrrev_b32 v3, 5, v1
  v_lshlrev_b32 v1, 4, v1
  v_mov_b32 v32, 161812
  ds_read_b32 v33, v32
  s_lshl_b32 s61, s46, 1
  s_add_u32 s60, s61, 2
  s_and_b32 s60, s60, 7
  s_mul_i32 s60, s60, 1536
  s_add_u32 s60, s60, 149504
  v_add_u32 v36, s60, v1
  v_add_u32 v37, s60, v2
  ds_read_b128 v[80:83], v36
  ds_read_b64 v[84:85], v37 offset:1024
  s_add_u32 s60, s61, 3
  s_and_b32 s60, s60, 7
  s_mul_i32 s60, s60, 1536
  s_add_u32 s60, s60, 149504
  v_add_u32 v36, s60, v1
  v_add_u32 v37, s60, v2
  ds_read_b128 v[86:89], v36
  ds_read_b64 v[90:91], v37 offset:1024
  s_add_u32 s60, s61, 4
  s_and_b32 s60, s60, 7
  s_mul_i32 s60, s60, 1536
  s_add_u32 s60, s60, 149504
  v_add_u32 v36, s60, v1
  v_add_u32 v37, s60, v2
  ds_read_b128 v[92:95], v36
  ds_read_b64 v[96:97], v37 offset:1024
  s_add_u32 s60, s61, 5
  s_and_b32 s60, s60, 7
  s_mul_i32 s60, s60, 1536
  s_add_u32 s60, s60, 149504
  v_add_u32 v36, s60, v1
  v_add_u32 v37, s60, v2
  ds_read_b128 v[98:101], v36
  ds_read_b64 v[102:103], v37 offset:1024
  s_add_u32 s60, s61, 6
  s_and_b32 s60, s60, 7
  s_mul_i32 s60, s60, 1536
  s_add_u32 s60, s60, 149504
  v_add_u32 v36, s60, v1
  v_add_u32 v37, s60, v2
  ds_read_b128 v[104:107], v36
  ds_read_b64 v[108:109], v37 offset:1024
  s_add_u32 s60, s61, 7
  s_and_b32 s60, s60, 7
  s_mul_i32 s60, s60, 1536
  s_add_u32 s60, s60, 149504
  v_add_u32 v36, s60, v1
  v_add_u32 v37, s60, v2
  ds_read_b128 v[110:113], v36
  ds_read_b64 v[114:115], v37 offset:1024
  s_add_u32 s60, s61, 8
  s_and_b32 s60, s60, 7
  s_mul_i32 s60, s60, 1536
  s_add_u32 s60, s60, 149504
  v_add_u32 v36, s60, v1
  v_add_u32 v37, s60, v2
  ds_read_b128 v[116:119], v36
  ds_read_b64 v[120:121], v37 offset:1024
  s_add_u32 s60, s61, 9
  s_and_b32 s60, s60, 7
  s_mul_i32 s60, s60, 1536
  s_add_u32 s60, s60, 149504
  v_add_u32 v36, s60, v1
  v_add_u32 v37, s60, v2
  ds_read_b128 v[122:125], v36
  ds_read_b64 v[126:127], v37 offset:1024
  v_mov_b32 v64, 0
  v_mov_b32 v65, 0
  v_mov_b32 v66, 0
  v_mov_b32 v67, 0
  v_mov_b32 v68, 0
  v_mov_b32 v69, 0
  v_mov_b32 v70, 0
  v_mov_b32 v71, 0
  v_mov_b32 v72, 0
  v_mov_b32 v73, 0
  v_mov_b32 v74, 0
  v_mov_b32 v75, 0
  v_mov_b32 v76, 0
  v_mov_b32 v77, 0
  v_mov_b32 v78, 0
  v_mov_b32 v79, 0
  v_mov_b32 v18, 0
  v_mov_b32 v19, 0
  v_mov_b32 v20, 0
  v_mov_b32 v21, 0
  v_mov_b32 v22, 0
  v_mov_b32 v23, 0
  v_mov_b32 v24, 0
  v_mov_b32 v25, 0
  v_mov_b32 v26, 0
  v_mov_b32 v27, 0
  v_mov_b32 v28, 0
  v_mov_b32 v29, 0
  v_mov_b32 v30, 0
  v_mov_b32 v31, 0
  v_mov_b32 v0, 0xdddddddd
  s_waitcnt lgkmcnt(0)
  v_cmp_eq_u32 vcc, 1, v3
  v_mul_f32 v36, v84, v33
  v_sqrt_f32 v36, v36
  s_nop 0
  v_mul_f32 v36, 0xbf820000, v36
  v_add_f32 v36, 0x42800000, v36
  v_lshrrev_b32 v36, 16, v36
  v_cndmask_b32 v84, v84, v36, vcc
  v_mul_f32 v36, v90, v33
  v_sqrt_f32 v36, v36
  s_nop 0
  v_mul_f32 v36, 0xbf820000, v36
  v_add_f32 v36, 0x42800000, v36
  v_lshrrev_b32 v36, 16, v36
  v_cndmask_b32 v90, v90, v36, vcc
  v_mul_f32 v36, v96, v33
  v_sqrt_f32 v36, v36
  s_nop 0
  v_mul_f32 v36, 0xbf820000, v36
  v_add_f32 v36, 0x42800000, v36
  v_lshrrev_b32 v36, 16, v36
  v_cndmask_b32 v96, v96, v36, vcc
  v_mul_f32 v36, v102, v33
  v_sqrt_f32 v36, v36
  s_nop 0
  v_mul_f32 v36, 0xbf820000, v36
  v_add_f32 v36, 0x42800000, v36
  v_lshrrev_b32 v36, 16, v36
  v_cndmask_b32 v102, v102, v36, vcc
  v_mul_f32 v36, v108, v33
  v_sqrt_f32 v36, v36
  s_nop 0
  v_mul_f32 v36, 0xbf820000, v36
  v_add_f32 v36, 0x42800000, v36
  v_lshrrev_b32 v36, 16, v36
  v_cndmask_b32 v108, v108, v36, vcc
  v_mul_f32 v36, v114, v33
  v_sqrt_f32 v36, v36
  s_nop 0
  v_mul_f32 v36, 0xbf820000, v36
  v_add_f32 v36, 0x42800000, v36
  v_lshrrev_b32 v36, 16, v36
  v_cndmask_b32 v114, v114, v36, vcc
  v_mul_f32 v36, v120, v33
  v_sqrt_f32 v36, v36
  s_nop 0
  v_mul_f32 v36, 0xbf820000, v36
  v_add_f32 v36, 0x42800000, v36
  v_lshrrev_b32 v36, 16, v36
  v_cndmask_b32 v120, v120, v36, vcc
  v_mul_f32 v36, v126, v33
  v_sqrt_f32 v36, v36
  s_nop 0
  v_mul_f32 v36, 0xbf820000, v36
  v_add_f32 v36, 0x42800000, v36
  v_lshrrev_b32 v36, 16, v36
  v_cndmask_b32 v126, v126, v36, vcc
  s_waitcnt vmcnt(0)
  v_mfma_f32_32x32x16_bf16 v[48:63], v[4:7], v[80:83], 0
  v_mfma_f32_32x32x8_bf16 v[48:63], v[16:17], v[84:85], v[48:63]
  s_nop 15
  s_add_u32 s60, s46, 1
  s_and_b32 s60, s60, 3
  s_mul_i32 s60, s60, 18432
  s_add_u32 s60, s60, 0
  v_add_u32 v32, s60, v1
  s_add_u32 s60, s46, 1
  s_and_b32 s60, s60, 3
  s_mul_i32 s60, s60, 18432
  s_add_u32 s60, s60, 3072
  v_add_u32 v33, s60, v1
  s_add_u32 s60, s46, 2
  s_and_b32 s60, s60, 3
  s_mul_i32 s60, s60, 18432
  s_add_u32 s60, s60, 6144
  v_add_u32 v34, s60, v1
  s_add_u32 s60, s46, 2
  s_and_b32 s60, s60, 3
  s_mul_i32 s60, s60, 18432
  s_add_u32 s60, s60, 9216
  v_add_u32 v35, s60, v1
  s_add_u32 s60, s46, 3
  s_and_b32 s60, s60, 3
  s_mul_i32 s60, s60, 18432
  s_add_u32 s60, s60, 12288
  v_add_u32 v36, s60, v1
  s_add_u32 s60, s46, 3
  s_and_b32 s60, s60, 3
  s_mul_i32 s60, s60, 18432
  s_add_u32 s60, s60, 15360
  v_add_u32 v37, s60, v1
  s_mov_b32 s68, s65
AT_loop:
  v_exp_f32 v48, v48
  v_exp_f32 v49, v49
  v_smfmac_f32_32x32x32_bf16 v[240:255], v[26:29], v[72:79], v0
  buffer_load_dwordx4 v[18:21], v1, s[8:11], s66 offen offset:0 sc1
  buffer_load_dwordx2 v[30:31], v2, s[8:11], s66 offen offset:3072 sc1
  buffer_load_dwordx4 v[22:25], v1, s[8:11], s66 offen offset:1024 sc1
  buffer_load_dwordx4 v[26:29], v1, s[8:11], s66 offen offset:2048 sc1
  s_add_u32 s66, s66, 3584
  v_exp_f32 v50, v50
  v_exp_f32 v51, v51
  v_exp_f32 v52, v52
  v_mfma_f32_32x32x16_bf16 v[64:79], v[4:7], v[86:89], 0
  v_exp_f32 v53, v53
  v_exp_f32 v54, v54
  v_exp_f32 v55, v55
  v_mfma_f32_32x32x8_bf16 v[64:79], v[16:17], v[90:91], v[64:79]
  v_exp_f32 v56, v56
  v_exp_f32 v57, v57
  v_exp_f32 v58, v58
  v_exp_f32 v59, v59
  v_smfmac_f32_32x32x32_bf16 v[128:143], v[8:11], v[48:55], v0
  v_exp_f32 v60, v60
  v_exp_f32 v61, v61
  v_exp_f32 v62, v62
  v_exp_f32 v63, v63
  v_exp_f32 v64, v64
  v_exp_f32 v65, v65
  v_smfmac_f32_32x32x32_bf16 v[128:143], v[12:15], v[56:63], v0
  v_exp_f32 v66, v66
  v_exp_f32 v67, v67
  v_exp_f32 v68, v68
  v_mfma_f32_32x32x16_bf16 v[48:63], v[4:7], v[92:95], 0
  v_exp_f32 v69, v69
  v_exp_f32 v70, v70
  v_exp_f32 v71, v71
  v_mfma_f32_32x32x8_bf16 v[48:63], v[16:17], v[96:97], v[48:63]
  v_exp_f32 v72, v72
  v_exp_f32 v73, v73
  v_exp_f32 v74, v74
  v_exp_f32 v75, v75
  v_smfmac_f32_32x32x32_bf16 v[144:159], v[8:11], v[64:71], v0
  v_exp_f32 v76, v76
  v_exp_f32 v77, v77
  v_exp_f32 v78, v78
  v_exp_f32 v79, v79
  v_exp_f32 v48, v48
  v_exp_f32 v49, v49
  v_smfmac_f32_32x32x32_bf16 v[144:159], v[12:15], v[72:79], v0
  v_exp_f32 v50, v50
  v_exp_f32 v51, v51
  v_exp_f32 v52, v52
  v_mfma_f32_32x32x16_bf16 v[64:79], v[4:7], v[98:101], 0
  v_exp_f32 v53, v53
  v_exp_f32 v54, v54
  v_exp_f32 v55, v55
  v_mfma_f32_32x32x8_bf16 v[64:79], v[16:17], v[102:103], v[64:79]
  v_exp_f32 v56, v56
  v_exp_f32 v57, v57
  v_exp_f32 v58, v58
  v_exp_f32 v59, v59
  v_smfmac_f32_32x32x32_bf16 v[160:175], v[8:11], v[48:55], v0
  v_exp_f32 v60, v60
  v_exp_f32 v61, v61
  v_exp_f32 v62, v62
  v_exp_f32 v63, v63
  v_exp_f32 v64, v64
  v_exp_f32 v65, v65
  v_smfmac_f32_32x32x32_bf16 v[160:175], v[12:15], v[56:63], v0
  v_exp_f32 v66, v66
  v_exp_f32 v67, v67
  v_exp_f32 v68, v68
  v_mfma_f32_32x32x16_bf16 v[48:63], v[4:7], v[104:107], 0
  v_exp_f32 v69, v69
  v_exp_f32 v70, v70
  v_exp_f32 v71, v71
  v_mfma_f32_32x32x8_bf16 v[48:63], v[16:17], v[108:109], v[48:63]
  v_exp_f32 v72, v72
  v_exp_f32 v73, v73
  v_exp_f32 v74, v74
  v_exp_f32 v75, v75
  v_smfmac_f32_32x32x32_bf16 v[176:191], v[8:11], v[64:71], v0
  v_exp_f32 v76, v76
  v_exp_f32 v77, v77
  v_exp_f32 v78, v78
  v_exp_f32 v79, v79
  v_exp_f32 v48, v48
  v_exp_f32 v49, v49
  v_smfmac_f32_32x32x32_bf16 v[176:191], v[12:15], v[72:79], v0
  v_exp_f32 v50, v50
  v_exp_f32 v51, v51
  v_exp_f32 v52, v52
  v_mfma_f32_32x32x16_bf16 v[64:79], v[4:7], v[110:113], 0
  v_exp_f32 v53, v53
  v_exp_f32 v54, v54
  v_exp_f32 v55, v55
  v_mfma_f32_32x32x8_bf16 v[64:79], v[16:17], v[114:115], v[64:79]
  v_exp_f32 v56, v56
  v_exp_f32 v57, v57
  v_exp_f32 v58, v58
  v_exp_f32 v59, v59
  v_smfmac_f32_32x32x32_bf16 v[192:207], v[8:11], v[48:55], v0
  v_exp_f32 v60, v60
  v_exp_f32 v61, v61
  v_exp_f32 v62, v62
  v_exp_f32 v63, v63
  v_exp_f32 v64, v64
  v_exp_f32 v65, v65
  v_smfmac_f32_32x32x32_bf16 v[192:207], v[12:15], v[56:63], v0
  v_exp_f32 v66, v66
  v_exp_f32 v67, v67
  v_exp_f32 v68, v68
  v_mfma_f32_32x32x16_bf16 v[48:63], v[4:7], v[116:119], 0
  v_exp_f32 v69, v69
  v_exp_f32 v70, v70
  v_exp_f32 v71, v71
  v_mfma_f32_32x32x8_bf16 v[48:63], v[16:17], v[120:121], v[48:63]
  v_exp_f32 v72, v72
  v_exp_f32 v73, v73
  v_exp_f32 v74, v74
  v_exp_f32 v75, v75
  v_smfmac_f32_32x32x32_bf16 v[208:223], v[8:11], v[64:71], v0
  v_exp_f32 v76, v76
  v_exp_f32 v77, v77
  v_exp_f32 v78, v78
  v_exp_f32 v79, v79
  v_exp_f32 v48, v48
  v_exp_f32 v49, v49
  v_smfmac_f32_32x32x32_bf16 v[208:223], v[12:15], v[72:79], v0
  v_exp_f32 v50, v50
  v_exp_f32 v51, v51
  v_exp_f32 v52, v52
  v_mfma_f32_32x32x16_bf16 v[64:79], v[4:7], v[122:125], 0
  v_exp_f32 v53, v53
  v_exp_f32 v54, v54
  v_exp_f32 v55, v55
  v_mfma_f32_32x32x8_bf16 v[64:79], v[16:17], v[126:127], v[64:79]
  v_exp_f32 v56, v56
  v_exp_f32 v57, v57
  v_exp_f32 v58, v58
  v_exp_f32 v59, v59
  v_smfmac_f32_32x32x32_bf16 v[224:239], v[8:11], v[48:55], v0
  v_exp_f32 v60, v60
  v_exp_f32 v61, v61
  v_exp_f32 v62, v62
  v_exp_f32 v63, v63
  v_exp_f32 v64, v64
  v_exp_f32 v65, v65
  v_smfmac_f32_32x32x32_bf16 v[224:239], v[12:15], v[56:63], v0
  v_exp_f32 v66, v66
  v_exp_f32 v67, v67
  v_exp_f32 v68, v68
  s_waitcnt vmcnt(0)
  v_mfma_f32_32x32x16_bf16 v[48:63], v[18:21], v[80:83], 0
  v_exp_f32 v69, v69
  v_exp_f32 v70, v70
  v_exp_f32 v71, v71
  v_mfma_f32_32x32x8_bf16 v[48:63], v[30:31], v[84:85], v[48:63]
  v_exp_f32 v72, v72
  v_exp_f32 v73, v73
  v_exp_f32 v74, v74
  v_exp_f32 v75, v75
  v_smfmac_f32_32x32x32_bf16 v[240:255], v[8:11], v[64:71], v0
  v_exp_f32 v76, v76
  v_exp_f32 v77, v77
  v_exp_f32 v78, v78
  v_exp_f32 v79, v79
  s_sub_u32 s68, s68, 1
  s_cmp_eq_u32 s68, 1
  s_cbranch_scc1 AT_last1
  v_exp_f32 v48, v48
  v_exp_f32 v49, v49
  v_smfmac_f32_32x32x32_bf16 v[240:255], v[12:15], v[72:79], v0
  buffer_load_dwordx4 v[4:7], v1, s[8:11], s66 offen offset:0 sc1
  buffer_load_dwordx2 v[16:17], v2, s[8:11], s66 offen offset:3072 sc1
  buffer_load_dwordx4 v[8:11], v1, s[8:11], s66 offen offset:1024 sc1
  buffer_load_dwordx4 v[12:15], v1, s[8:11], s66 offen offset:2048 sc1
  s_add_u32 s66, s66, 3584
  v_exp_f32 v50, v50
  v_exp_f32 v51, v51
  v_exp_f32 v52, v52
  v_mfma_f32_32x32x16_bf16 v[64:79], v[18:21], v[86:89], 0
  v_exp_f32 v53, v53
  v_exp_f32 v54, v54
  v_exp_f32 v55, v55
  v_mfma_f32_32x32x8_bf16 v[64:79], v[30:31], v[90:91], v[64:79]
  v_exp_f32 v56, v56
  v_exp_f32 v57, v57
  v_exp_f32 v58, v58
  v_exp_f32 v59, v59
  v_smfmac_f32_32x32x32_bf16 v[128:143], v[22:25], v[48:55], v0
  v_exp_f32 v60, v60
  v_exp_f32 v61, v61
  v_exp_f32 v62, v62
  v_exp_f32 v63, v63
  v_exp_f32 v64, v64
  v_exp_f32 v65, v65
  v_smfmac_f32_32x32x32_bf16 v[128:143], v[26:29], v[56:63], v0
  v_exp_f32 v66, v66
  v_exp_f32 v67, v67
  v_exp_f32 v68, v68
  v_mfma_f32_32x32x16_bf16 v[48:63], v[18:21], v[92:95], 0
  v_exp_f32 v69, v69
  v_exp_f32 v70, v70
  v_exp_f32 v71, v71
  v_mfma_f32_32x32x8_bf16 v[48:63], v[30:31], v[96:97], v[48:63]
  v_exp_f32 v72, v72
  v_exp_f32 v73, v73
  v_exp_f32 v74, v74
  v_exp_f32 v75, v75
  v_smfmac_f32_32x32x32_bf16 v[144:159], v[22:25], v[64:71], v0
  v_exp_f32 v76, v76
  v_exp_f32 v77, v77
  v_exp_f32 v78, v78
  v_exp_f32 v79, v79
  v_exp_f32 v48, v48
  v_exp_f32 v49, v49
  v_smfmac_f32_32x32x32_bf16 v[144:159], v[26:29], v[72:79], v0
  v_exp_f32 v50, v50
  v_exp_f32 v51, v51
  v_exp_f32 v52, v52
  v_mfma_f32_32x32x16_bf16 v[64:79], v[18:21], v[98:101], 0
  v_exp_f32 v53, v53
  v_exp_f32 v54, v54
  v_exp_f32 v55, v55
  v_mfma_f32_32x32x8_bf16 v[64:79], v[30:31], v[102:103], v[64:79]
  v_exp_f32 v56, v56
  v_exp_f32 v57, v57
  v_exp_f32 v58, v58
  v_exp_f32 v59, v59
  v_smfmac_f32_32x32x32_bf16 v[160:175], v[22:25], v[48:55], v0
  v_exp_f32 v60, v60
  v_exp_f32 v61, v61
  v_exp_f32 v62, v62
  v_exp_f32 v63, v63
  v_exp_f32 v64, v64
  v_exp_f32 v65, v65
  v_smfmac_f32_32x32x32_bf16 v[160:175], v[26:29], v[56:63], v0
  v_exp_f32 v66, v66
  v_exp_f32 v67, v67
  v_exp_f32 v68, v68
  v_mfma_f32_32x32x16_bf16 v[48:63], v[18:21], v[104:107], 0
  v_exp_f32 v69, v69
  v_exp_f32 v70, v70
  v_exp_f32 v71, v71
  v_mfma_f32_32x32x8_bf16 v[48:63], v[30:31], v[108:109], v[48:63]
  v_exp_f32 v72, v72
  v_exp_f32 v73, v73
  v_exp_f32 v74, v74
  v_exp_f32 v75, v75
  v_smfmac_f32_32x32x32_bf16 v[176:191], v[22:25], v[64:71], v0
  v_exp_f32 v76, v76
  v_exp_f32 v77, v77
  v_exp_f32 v78, v78
  v_exp_f32 v79, v79
  v_exp_f32 v48, v48
  v_exp_f32 v49, v49
  v_smfmac_f32_32x32x32_bf16 v[176:191], v[26:29], v[72:79], v0
  v_exp_f32 v50, v50
  v_exp_f32 v51, v51
  v_exp_f32 v52, v52
  v_mfma_f32_32x32x16_bf16 v[64:79], v[18:21], v[110:113], 0
  v_exp_f32 v53, v53
  v_exp_f32 v54, v54
  v_exp_f32 v55, v55
  v_mfma_f32_32x32x8_bf16 v[64:79], v[30:31], v[114:115], v[64:79]
  v_exp_f32 v56, v56
  v_exp_f32 v57, v57
  v_exp_f32 v58, v58
  v_exp_f32 v59, v59
  v_smfmac_f32_32x32x32_bf16 v[192:207], v[22:25], v[48:55], v0
  v_exp_f32 v60, v60
  v_exp_f32 v61, v61
  v_exp_f32 v62, v62
  v_exp_f32 v63, v63
  v_exp_f32 v64, v64
  v_exp_f32 v65, v65
  v_smfmac_f32_32x32x32_bf16 v[192:207], v[26:29], v[56:63], v0
  v_exp_f32 v66, v66
  v_exp_f32 v67, v67
  v_exp_f32 v68, v68
  v_mfma_f32_32x32x16_bf16 v[48:63], v[18:21], v[116:119], 0
  v_exp_f32 v69, v69
  v_exp_f32 v70, v70
  v_exp_f32 v71, v71
  v_mfma_f32_32x32x8_bf16 v[48:63], v[30:31], v[120:121], v[48:63]
  v_exp_f32 v72, v72
  v_exp_f32 v73, v73
  v_exp_f32 v74, v74
  v_exp_f32 v75, v75
  v_smfmac_f32_32x32x32_bf16 v[208:223], v[22:25], v[64:71], v0
  v_exp_f32 v76, v76
  v_exp_f32 v77, v77
  v_exp_f32 v78, v78
  v_exp_f32 v79, v79
  v_exp_f32 v48, v48
  v_exp_f32 v49, v49
  v_smfmac_f32_32x32x32_bf16 v[208:223], v[26:29], v[72:79], v0
  v_exp_f32 v50, v50
  v_exp_f32 v51, v51
  v_exp_f32 v52, v52
  v_mfma_f32_32x32x16_bf16 v[64:79], v[18:21], v[122:125], 0
  v_exp_f32 v53, v53
  v_exp_f32 v54, v54
  v_exp_f32 v55, v55
  v_mfma_f32_32x32x8_bf16 v[64:79], v[30:31], v[126:127], v[64:79]
  v_exp_f32 v56, v56
  v_exp_f32 v57, v57
  v_exp_f32 v58, v58
  v_exp_f32 v59, v59
  v_smfmac_f32_32x32x32_bf16 v[224:239], v[22:25], v[48:55], v0
  v_exp_f32 v60, v60
  v_exp_f32 v61, v61
  v_exp_f32 v62, v62
  v_exp_f32 v63, v63
  v_exp_f32 v64, v64
  v_exp_f32 v65, v65
  v_smfmac_f32_32x32x32_bf16 v[224:239], v[26:29], v[56:63], v0
  v_exp_f32 v66, v66
  v_exp_f32 v67, v67
  v_exp_f32 v68, v68
  s_waitcnt vmcnt(0)
  v_mfma_f32_32x32x16_bf16 v[48:63], v[4:7], v[80:83], 0
  v_exp_f32 v69, v69
  v_exp_f32 v70, v70
  v_exp_f32 v71, v71
  v_mfma_f32_32x32x8_bf16 v[48:63], v[16:17], v[84:85], v[48:63]
  v_exp_f32 v72, v72
  v_exp_f32 v73, v73
  v_exp_f32 v74, v74
  v_exp_f32 v75, v75
  v_smfmac_f32_32x32x32_bf16 v[240:255], v[22:25], v[64:71], v0
  v_exp_f32 v76, v76
  v_exp_f32 v77, v77
  v_exp_f32 v78, v78
  v_exp_f32 v79, v79
  s_sub_u32 s68, s68, 1
  s_cmp_lg_u32 s68, 1
  s_cbranch_scc1 AT_loop
  v_exp_f32 v48, v48
  v_exp_f32 v49, v49
  v_smfmac_f32_32x32x32_bf16 v[240:255], v[26:29], v[72:79], v0
  v_exp_f32 v50, v50
  v_exp_f32 v51, v51
  v_exp_f32 v52, v52
  v_mfma_f32_32x32x16_bf16 v[64:79], v[4:7], v[86:89], 0
  v_exp_f32 v53, v53
  v_exp_f32 v54, v54
  v_exp_f32 v55, v55
  v_mfma_f32_32x32x8_bf16 v[64:79], v[16:17], v[90:91], v[64:79]
  v_exp_f32 v56, v56
  v_exp_f32 v57, v57
  v_exp_f32 v58, v58
  v_exp_f32 v59, v59
  v_smfmac_f32_32x32x32_bf16 v[128:143], v[8:11], v[48:55], v0
  v_exp_f32 v60, v60
  v_exp_f32 v61, v61
  v_exp_f32 v62, v62
  v_exp_f32 v63, v63
  v_exp_f32 v64, v64
  v_exp_f32 v65, v65
  v_smfmac_f32_32x32x32_bf16 v[128:143], v[12:15], v[56:63], v0
  v_exp_f32 v66, v66
  v_exp_f32 v67, v67
  v_exp_f32 v68, v68
  v_mfma_f32_32x32x16_bf16 v[48:63], v[4:7], v[92:95], 0
  v_exp_f32 v69, v69
  v_exp_f32 v70, v70
  v_exp_f32 v71, v71
  v_mfma_f32_32x32x8_bf16 v[48:63], v[16:17], v[96:97], v[48:63]
  v_exp_f32 v72, v72
  v_exp_f32 v73, v73
  v_exp_f32 v74, v74
  v_exp_f32 v75, v75
  v_smfmac_f32_32x32x32_bf16 v[144:159], v[8:11], v[64:71], v0
  v_exp_f32 v76, v76
  v_exp_f32 v77, v77
  v_exp_f32 v78, v78
  v_exp_f32 v79, v79
  v_exp_f32 v48, v48
  v_exp_f32 v49, v49
  v_smfmac_f32_32x32x32_bf16 v[144:159], v[12:15], v[72:79], v0
  v_exp_f32 v50, v50
  v_exp_f32 v51, v51
  ds_write_b128 v32, v[128:131] offset:0
  v_exp_f32 v52, v52
  v_mfma_f32_32x32x16_bf16 v[64:79], v[4:7], v[98:101], 0
  v_exp_f32 v53, v53
  v_exp_f32 v54, v54
  v_exp_f32 v55, v55
  ds_write_b128 v32, v[132:135] offset:1024
  v_mfma_f32_32x32x8_bf16 v[64:79], v[16:17], v[102:103], v[64:79]
  v_exp_f32 v56, v56
  v_exp_f32 v57, v57
  v_exp_f32 v58, v58
  v_exp_f32 v59, v59
  v_smfmac_f32_32x32x32_bf16 v[160:175], v[8:11], v[48:55], v0
  v_exp_f32 v60, v60
  ds_write_b128 v32, v[136:139] offset:2048
  v_exp_f32 v61, v61
  v_exp_f32 v62, v62
  v_exp_f32 v63, v63
  v_exp_f32 v64, v64
  v_exp_f32 v65, v65
  v_smfmac_f32_32x32x32_bf16 v[160:175], v[12:15], v[56:63], v0
  v_exp_f32 v66, v66
  v_exp_f32 v67, v67
  ds_write_b128 v33, v[144:147] offset:0
  v_exp_f32 v68, v68
  v_mfma_f32_32x32x16_bf16 v[48:63], v[4:7], v[104:107], 0
  v_exp_f32 v69, v69
  v_exp_f32 v70, v70
  v_exp_f32 v71, v71
  ds_write_b128 v33, v[148:151] offset:1024
  v_mfma_f32_32x32x8_bf16 v[48:63], v[16:17], v[108:109], v[48:63]
  v_exp_f32 v72, v72
  v_exp_f32 v73, v73
  v_exp_f32 v74, v74
  v_exp_f32 v75, v75
  v_smfmac_f32_32x32x32_bf16 v[176:191], v[8:11], v[64:71], v0
  v_exp_f32 v76, v76
  ds_write_b128 v33, v[152:155] offset:2048
  v_exp_f32 v77, v77
  v_exp_f32 v78, v78
  v_exp_f32 v79, v79
  v_exp_f32 v48, v48
  v_exp_f32 v49, v49
  v_smfmac_f32_32x32x32_bf16 v[176:191], v[12:15], v[72:79], v0
  v_exp_f32 v50, v50
  v_exp_f32 v51, v51
  ds_write_b128 v34, v[160:163] offset:0
  v_exp_f32 v52, v52
  v_mfma_f32_32x32x16_bf16 v[64:79], v[4:7], v[110:113], 0
  v_exp_f32 v53, v53
  v_exp_f32 v54, v54
  v_exp_f32 v55, v55
  ds_write_b128 v34, v[164:167] offset:1024
  v_mfma_f32_32x32x8_bf16 v[64:79], v[16:17], v[114:115], v[64:79]
  v_exp_f32 v56, v56
  v_exp_f32 v57, v57
  v_exp_f32 v58, v58
  v_exp_f32 v59, v59
  v_smfmac_f32_32x32x32_bf16 v[192:207], v[8:11], v[48:55], v0
  v_exp_f32 v60, v60
  ds_write_b128 v34, v[168:171] offset:2048
  v_exp_f32 v61, v61
  v_exp_f32 v62, v62
  v_exp_f32 v63, v63
  v_exp_f32 v64, v64
  v_exp_f32 v65, v65
  v_smfmac_f32_32x32x32_bf16 v[192:207], v[12:15], v[56:63], v0
  v_exp_f32 v66, v66
  v_exp_f32 v67, v67
  ds_write_b128 v35, v[176:179] offset:0
  v_exp_f32 v68, v68
  v_mfma_f32_32x32x16_bf16 v[48:63], v[4:7], v[116:119], 0
  v_exp_f32 v69, v69
  v_exp_f32 v70, v70
  v_exp_f32 v71, v71
  ds_write_b128 v35, v[180:183] offset:1024
  v_mfma_f32_32x32x8_bf16 v[48:63], v[16:17], v[120:121], v[48:63]
  v_exp_f32 v72, v72
  v_exp_f32 v73, v73
  v_exp_f32 v74, v74
  v_exp_f32 v75, v75
  v_smfmac_f32_32x32x32_bf16 v[208:223], v[8:11], v[64:71], v0
  v_exp_f32 v76, v76
  ds_write_b128 v35, v[184:187] offset:2048
  v_exp_f32 v77, v77
  v_exp_f32 v78, v78
  v_exp_f32 v79, v79
  v_exp_f32 v48, v48
  v_exp_f32 v49, v49
  v_smfmac_f32_32x32x32_bf16 v[208:223], v[12:15], v[72:79], v0
  v_exp_f32 v50, v50
  v_exp_f32 v51, v51
  ds_write_b128 v36, v[192:195] offset:0
  v_exp_f32 v52, v52
  v_mfma_f32_32x32x16_bf16 v[64:79], v[4:7], v[122:125], 0
  v_exp_f32 v53, v53
  v_exp_f32 v54, v54
  v_exp_f32 v55, v55
  ds_write_b128 v36, v[196:199] offset:1024
  v_mfma_f32_32x32x8_bf16 v[64:79], v[16:17], v[126:127], v[64:79]
  v_exp_f32 v56, v56
  v_exp_f32 v57, v57
  v_exp_f32 v58, v58
  v_exp_f32 v59, v59
  v_smfmac_f32_32x32x32_bf16 v[224:239], v[8:11], v[48:55], v0
  v_exp_f32 v60, v60
  ds_write_b128 v36, v[200:203] offset:2048
  v_exp_f32 v61, v61
  v_exp_f32 v62, v62
  v_exp_f32 v63, v63
  v_exp_f32 v64, v64
  v_exp_f32 v65, v65
  v_smfmac_f32_32x32x32_bf16 v[224:239], v[12:15], v[56:63], v0
  v_exp_f32 v66, v66
  v_exp_f32 v67, v67
  ds_write_b128 v37, v[208:211] offset:0
  v_exp_f32 v68, v68
  v_exp_f32 v69, v69
  v_exp_f32 v70, v70
  v_exp_f32 v71, v71
  ds_write_b128 v37, v[212:215] offset:1024
  v_exp_f32 v72, v72
  v_exp_f32 v73, v73
  v_exp_f32 v74, v74
  v_exp_f32 v75, v75
  v_smfmac_f32_32x32x32_bf16 v[240:255], v[8:11], v[64:71], v0
  v_exp_f32 v76, v76
  ds_write_b128 v37, v[216:219] offset:2048
  v_exp_f32 v77, v77
  v_exp_f32 v78, v78
  v_exp_f32 v79, v79
  s_nop 1
  v_smfmac_f32_32x32x32_bf16 v[240:255], v[12:15], v[72:79], v0
  s_branch AT_done
AT_last1:
  v_exp_f32 v48, v48
  v_exp_f32 v49, v49
  v_smfmac_f32_32x32x32_bf16 v[240:255], v[12:15], v[72:79], v0
  v_exp_f32 v50, v50
  v_exp_f32 v51, v51
  v_exp_f32 v52, v52
  v_mfma_f32_32x32x16_bf16 v[64:79], v[18:21], v[86:89], 0
  v_exp_f32 v53, v53
  v_exp_f32 v54, v54
  v_exp_f32 v55, v55
  v_mfma_f32_32x32x8_bf16 v[64:79], v[30:31], v[90:91], v[64:79]
  v_exp_f32 v56, v56
  v_exp_f32 v57, v57
  v_exp_f32 v58, v58
  v_exp_f32 v59, v59
  v_smfmac_f32_32x32x32_bf16 v[128:143], v[22:25], v[48:55], v0
  v_exp_f32 v60, v60
  v_exp_f32 v61, v61
  v_exp_f32 v62, v62
  v_exp_f32 v63, v63
  v_exp_f32 v64, v64
  v_exp_f32 v65, v65
  v_smfmac_f32_32x32x32_bf16 v[128:143], v[26:29], v[56:63], v0
  v_exp_f32 v66, v66
  v_exp_f32 v67, v67
  v_exp_f32 v68, v68
  v_mfma_f32_32x32x16_bf16 v[48:63], v[18:21], v[92:95], 0
  v_exp_f32 v69, v69
  v_exp_f32 v70, v70
  v_exp_f32 v71, v71
  v_mfma_f32_32x32x8_bf16 v[48:63], v[30:31], v[96:97], v[48:63]
  v_exp_f32 v72, v72
  v_exp_f32 v73, v73
  v_exp_f32 v74, v74
  v_exp_f32 v75, v75
  v_smfmac_f32_32x32x32_bf16 v[144:159], v[22:25], v[64:71], v0
  v_exp_f32 v76, v76
  v_exp_f32 v77, v77
  v_exp_f32 v78, v78
  v_exp_f32 v79, v79
  v_exp_f32 v48, v48
  v_exp_f32 v49, v49
  v_smfmac_f32_32x32x32_bf16 v[144:159], v[26:29], v[72:79], v0
  v_exp_f32 v50, v50
  v_exp_f32 v51, v51
  ds_write_b128 v32, v[128:131] offset:0
  v_exp_f32 v52, v52
  v_mfma_f32_32x32x16_bf16 v[64:79], v[18:21], v[98:101], 0
  v_exp_f32 v53, v53
  v_exp_f32 v54, v54
  v_exp_f32 v55, v55
  ds_write_b128 v32, v[132:135] offset:1024
  v_mfma_f32_32x32x8_bf16 v[64:79], v[30:31], v[102:103], v[64:79]
  v_exp_f32 v56, v56
  v_exp_f32 v57, v57
  v_exp_f32 v58, v58
  v_exp_f32 v59, v59
  v_smfmac_f32_32x32x32_bf16 v[160:175], v[22:25], v[48:55], v0
  v_exp_f32 v60, v60
  ds_write_b128 v32, v[136:139] offset:2048
  v_exp_f32 v61, v61
  v_exp_f32 v62, v62
  v_exp_f32 v63, v63
  v_exp_f32 v64, v64
  v_exp_f32 v65, v65
  v_smfmac_f32_32x32x32_bf16 v[160:175], v[26:29], v[56:63], v0
  v_exp_f32 v66, v66
  v_exp_f32 v67, v67
  ds_write_b128 v33, v[144:147] offset:0
  v_exp_f32 v68, v68
  v_mfma_f32_32x32x16_bf16 v[48:63], v[18:21], v[104:107], 0
  v_exp_f32 v69, v69
  v_exp_f32 v70, v70
  v_exp_f32 v71, v71
  ds_write_b128 v33, v[148:151] offset:1024
  v_mfma_f32_32x32x8_bf16 v[48:63], v[30:31], v[108:109], v[48:63]
  v_exp_f32 v72, v72
  v_exp_f32 v73, v73
  v_exp_f32 v74, v74
  v_exp_f32 v75, v75
  v_smfmac_f32_32x32x32_bf16 v[176:191], v[22:25], v[64:71], v0
  v_exp_f32 v76, v76
  ds_write_b128 v33, v[152:155] offset:2048
  v_exp_f32 v77, v77
  v_exp_f32 v78, v78
  v_exp_f32 v79, v79
  v_exp_f32 v48, v48
  v_exp_f32 v49, v49
  v_smfmac_f32_32x32x32_bf16 v[176:191], v[26:29], v[72:79], v0
  v_exp_f32 v50, v50
  v_exp_f32 v51, v51
  ds_write_b128 v34, v[160:163] offset:0
  v_exp_f32 v52, v52
  v_mfma_f32_32x32x16_bf16 v[64:79], v[18:21], v[110:113], 0
  v_exp_f32 v53, v53
  v_exp_f32 v54, v54
  v_exp_f32 v55, v55
  ds_write_b128 v34, v[164:167] offset:1024
  v_mfma_f32_32x32x8_bf16 v[64:79], v[30:31], v[114:115], v[64:79]
  v_exp_f32 v56, v56
  v_exp_f32 v57, v57
  v_exp_f32 v58, v58
  v_exp_f32 v59, v59
  v_smfmac_f32_32x32x32_bf16 v[192:207], v[22:25], v[48:55], v0
  v_exp_f32 v60, v60
  ds_write_b128 v34, v[168:171] offset:2048
  v_exp_f32 v61, v61
  v_exp_f32 v62, v62
  v_exp_f32 v63, v63
  v_exp_f32 v64, v64
  v_exp_f32 v65, v65
  v_smfmac_f32_32x32x32_bf16 v[192:207], v[26:29], v[56:63], v0
  v_exp_f32 v66, v66
  v_exp_f32 v67, v67
  ds_write_b128 v35, v[176:179] offset:0
  v_exp_f32 v68, v68
  v_mfma_f32_32x32x16_bf16 v[48:63], v[18:21], v[116:119], 0
  v_exp_f32 v69, v69
  v_exp_f32 v70, v70
  v_exp_f32 v71, v71
  ds_write_b128 v35, v[180:183] offset:1024
  v_mfma_f32_32x32x8_bf16 v[48:63], v[30:31], v[120:121], v[48:63]
  v_exp_f32 v72, v72
  v_exp_f32 v73, v73
  v_exp_f32 v74, v74
  v_exp_f32 v75, v75
  v_smfmac_f32_32x32x32_bf16 v[208:223], v[22:25], v[64:71], v0
  v_exp_f32 v76, v76
  ds_write_b128 v35, v[184:187] offset:2048
  v_exp_f32 v77, v77
  v_exp_f32 v78, v78
  v_exp_f32 v79, v79
  v_exp_f32 v48, v48
  v_exp_f32 v49, v49
  v_smfmac_f32_32x32x32_bf16 v[208:223], v[26:29], v[72:79], v0
  v_exp_f32 v50, v50
  v_exp_f32 v51, v51
  ds_write_b128 v36, v[192:195] offset:0
  v_exp_f32 v52, v52
  v_mfma_f32_32x32x16_bf16 v[64:79], v[18:21], v[122:125], 0
  v_exp_f32 v53, v53
  v_exp_f32 v54, v54
  v_exp_f32 v55, v55
  ds_write_b128 v36, v[196:199] offset:1024
  v_mfma_f32_32x32x8_bf16 v[64:79], v[30:31], v[126:127], v[64:79]
  v_exp_f32 v56, v56
  v_exp_f32 v57, v57
  v_exp_f32 v58, v58
  v_exp_f32 v59, v59
  v_smfmac_f32_32x32x32_bf16 v[224:239], v[22:25], v[48:55], v0
  v_exp_f32 v60, v60
  ds_write_b128 v36, v[200:203] offset:2048
  v_exp_f32 v61, v61
  v_exp_f32 v62, v62
  v_exp_f32 v63, v63
  v_exp_f32 v64, v64
  v_exp_f32 v65, v65
  v_smfmac_f32_32x32x32_bf16 v[224:239], v[26:29], v[56:63], v0
  v_exp_f32 v66, v66
  v_exp_f32 v67, v67
  ds_write_b128 v37, v[208:211] offset:0
  v_exp_f32 v68, v68
  v_exp_f32 v69, v69
  v_exp_f32 v70, v70
  v_exp_f32 v71, v71
  ds_write_b128 v37, v[212:215] offset:1024
  v_exp_f32 v72, v72
  v_exp_f32 v73, v73
  v_exp_f32 v74, v74
  v_exp_f32 v75, v75
  v_smfmac_f32_32x32x32_bf16 v[240:255], v[22:25], v[64:71], v0
  v_exp_f32 v76, v76
  ds_write_b128 v37, v[216:219] offset:2048
  v_exp_f32 v77, v77
  v_exp_f32 v78, v78
  v_exp_f32 v79, v79
  s_nop 1
  v_smfmac_f32_32x32x32_bf16 v[240:255], v[26:29], v[72:79], v0
AT_done:
  s_nop 15
  s_setprio 3
  s_waitcnt lgkmcnt(0)
  v_mov_b32 v32, 161828
  v_mov_b32 v33, 1
  s_mov_b64 exec, 1
  ds_add_u32 v32, v33
  s_mov_b64 exec, -1
  s_mov_b32 s57, 0
RB_spin:
  ds_read_b32 v34, v32
  s_waitcnt lgkmcnt(0)
  v_readfirstlane_b32 s60, v34
  s_nop 3
  s_cmp_ge_u32 s60, 4
  s_cbranch_scc1 RB_ok
  s_add_u32 s57, s57, 1
  s_cmp_ge_u32 s57, 4000000
  s_cbranch_scc1 RB_ok
  s_branch RB_spin
RB_ok:
  s_mul_i32 s60, s46, 18432
  v_add_u32 v32, s60, v1
  ds_read_b128 v[48:51], v32 offset:0
  ds_read_b128 v[52:55], v32 offset:1024
  ds_read_b128 v[56:59], v32 offset:2048
  ds_read_b128 v[72:75], v32 offset:6144
  ds_read_b128 v[76:79], v32 offset:7168
  ds_read_b128 v[80:83], v32 offset:8192
  ds_read_b128 v[96:99], v32 offset:12288
  ds_read_b128 v[100:103], v32 offset:13312
  ds_read_b128 v[104:107], v32 offset:14336
  ds_read_b128 v[60:63], v32 offset:3072
  ds_read_b128 v[64:67], v32 offset:4096
  ds_read_b128 v[68:71], v32 offset:5120
  ds_read_b128 v[84:87], v32 offset:9216
  ds_read_b128 v[88:91], v32 offset:10240
  ds_read_b128 v[92:95], v32 offset:11264
  ds_read_b128 v[108:111], v32 offset:15360
  ds_read_b128 v[112:115], v32 offset:16384
  ds_read_b128 v[116:119], v32 offset:17408
  s_waitcnt lgkmcnt(9)
  v_pk_add_f32 v[224:225], v[224:225], v[48:49]
  v_pk_add_f32 v[226:227], v[226:227], v[50:51]
  v_pk_add_f32 v[228:229], v[228:229], v[52:53]
  v_pk_add_f32 v[230:231], v[230:231], v[54:55]
  v_pk_add_f32 v[232:233], v[232:233], v[56:57]
  v_pk_add_f32 v[234:235], v[234:235], v[58:59]
  v_pk_add_f32 v[224:225], v[224:225], v[72:73]
  v_pk_add_f32 v[226:227], v[226:227], v[74:75]
  v_pk_add_f32 v[228:229], v[228:229], v[76:77]
  v_pk_add_f32 v[230:231], v[230:231], v[78:79]
  v_pk_add_f32 v[232:233], v[232:233], v[80:81]
  v_pk_add_f32 v[234:235], v[234:235], v[82:83]
  v_pk_add_f32 v[224:225], v[224:225], v[96:97]
  v_pk_add_f32 v[226:227], v[226:227], v[98:99]
  v_pk_add_f32 v[228:229], v[228:229], v[100:101]
  v_pk_add_f32 v[230:231], v[230:231], v[102:103]
  v_pk_add_f32 v[232:233], v[232:233], v[104:105]
  v_pk_add_f32 v[234:235], v[234:235], v[106:107]
  s_waitcnt lgkmcnt(0)
  v_pk_add_f32 v[240:241], v[240:241], v[60:61]
  v_pk_add_f32 v[242:243], v[242:243], v[62:63]
  v_pk_add_f32 v[244:245], v[244:245], v[64:65]
  v_pk_add_f32 v[246:247], v[246:247], v[66:67]
  v_pk_add_f32 v[248:249], v[248:249], v[68:69]
  v_pk_add_f32 v[250:251], v[250:251], v[70:71]
  v_pk_add_f32 v[240:241], v[240:241], v[84:85]
  v_pk_add_f32 v[242:243], v[242:243], v[86:87]
  v_pk_add_f32 v[244:245], v[244:245], v[88:89]
  v_pk_add_f32 v[246:247], v[246:247], v[90:91]
  v_pk_add_f32 v[248:249], v[248:249], v[92:93]
  v_pk_add_f32 v[250:251], v[250:251], v[94:95]
  v_pk_add_f32 v[240:241], v[240:241], v[108:109]
  v_pk_add_f32 v[242:243], v[242:243], v[110:111]
  v_pk_add_f32 v[244:245], v[244:245], v[112:113]
  v_pk_add_f32 v[246:247], v[246:247], v[114:115]
  v_pk_add_f32 v[248:249], v[248:249], v[116:117]
  v_pk_add_f32 v[250:251], v[250:251], v[118:119]
  s_lshl_b32 s60, s47, 3
  s_add_u32 s60, s60, s48
  s_mul_i32 s60, s60, 10240
  s_add_u32 s60, s60, 8388608
  s_lshl_b32 s61, s46, 10
  s_add_u32 s61, s61, s60
  s_lshl_b32 s62, s46, 8
  s_add_u32 s62, s62, s60
  s_add_u32 s62, s62, 4096
  s_mov_b32 s67, 0
L_norm:
  v_mov_b32 v32, v232
  v_mov_b32 v36, v232
  v_mov_b32 v33, v248
  v_mov_b32 v37, v248
  v_mov_b32 v34, 0x17800000
  v_mov_b32 v35, 0x7b800000
  v_permlane32_swap_b32 v32, v36
  v_permlane32_swap_b32 v33, v37
  s_nop 1
  v_med3_f32 v32, v36, v34, v35
  v_med3_f32 v33, v37, v34, v35
  v_rcp_f32 v40, v36
  v_rcp_f32 v42, v37
  v_cmp_eq_f32 vcc, v32, v36
  v_cmp_eq_f32 s[74:75], v33, v37
  v_mov_b32 v41, v40
  v_mov_b32 v43, v42
  s_nop 1
  s_and_b64 s[74:75], s[74:75], vcc
  s_cmp_eq_u64 s[74:75], -1
  s_cbranch_scc1 L_norm_ok
  s_cmp_eq_u32 s67, 0
  s_cbranch_scc1 L_fallback
L_norm_ok:
  v_pk_mul_f32 v[224:225], v[224:225], v[40:41]
  v_pk_mul_f32 v[226:227], v[226:227], v[40:41]
  v_pk_mul_f32 v[228:229], v[228:229], v[40:41]
  v_pk_mul_f32 v[230:231], v[230:231], v[40:41]
  v_pk_mul_f32 v[232:233], v[232:233], v[40:41]
  v_pk_mul_f32 v[234:235], v[234:235], v[40:41]
  v_cvt_pk_bf16_f32 v224, v224, v225
  v_cvt_pk_bf16_f32 v225, v226, v227
  v_cvt_pk_bf16_f32 v226, v228, v229
  v_cvt_pk_bf16_f32 v227, v230, v231
  v_cvt_pk_bf16_f32 v228, v232, v233
  v_cvt_pk_bf16_f32 v229, v234, v235
  buffer_store_dwordx4 v[224:227], v1, s[8:11], s61 offen sc1
  s_mov_b32 exec_hi, 0
  buffer_store_dwordx2 v[228:229], v2, s[8:11], s62 offen sc1
  s_mov_b32 exec_hi, -1
  s_add_u32 s61, s61, 5120
  s_add_u32 s62, s62, 5120
  v_pk_mul_f32 v[240:241], v[240:241], v[42:43]
  v_pk_mul_f32 v[242:243], v[242:243], v[42:43]
  v_pk_mul_f32 v[244:245], v[244:245], v[42:43]
  v_pk_mul_f32 v[246:247], v[246:247], v[42:43]
  v_pk_mul_f32 v[248:249], v[248:249], v[42:43]
  v_pk_mul_f32 v[250:251], v[250:251], v[42:43]
  v_cvt_pk_bf16_f32 v240, v240, v241
  v_cvt_pk_bf16_f32 v241, v242, v243
  v_cvt_pk_bf16_f32 v242, v244, v245
  v_cvt_pk_bf16_f32 v243, v246, v247
  v_cvt_pk_bf16_f32 v244, v248, v249
  v_cvt_pk_bf16_f32 v245, v250, v251
  buffer_store_dwordx4 v[240:243], v1, s[8:11], s61 offen sc1
  s_mov_b32 exec_hi, 0
  buffer_store_dwordx2 v[244:245], v2, s[8:11], s62 offen sc1
  s_mov_b32 exec_hi, -1
  v_mov_b32 v32, 161824
  v_mov_b32 v33, 1
  v_mov_b32 v36, s50
  v_mov_b32 v37, 0
  v_mov_b32 v38, 0
  s_lshl_b32 s61, s47, 3
  s_add_u32 s61, s61, s48
  s_lshl_b32 s61, s61, 7
  s_add_u32 s61, s61, 32768
  s_waitcnt vmcnt(0)
  s_mov_b64 exec, 1
  ds_add_rtn_u32 v34, v32, v33
  s_waitcnt lgkmcnt(0)
  v_readfirstlane_b32 s60, v34
  s_nop 3
  s_cmp_eq_u32 s60, 3
  s_cbranch_scc0 L_end
  buffer_store_dwordx2 v[36:37], v38, s[8:11], s61 offen sc1
  s_branch L_end
L_fallback:
  s_mov_b32 s67, 1
  s_mul_i32 s60, s46, 3072
  s_add_u32 s60, s60, 149504
  v_add_u32 v32, s60, v1
  v_add_u32 v33, s60, v2
  ds_read_b128 v[80:83], v32 offset:0
  ds_read_b64 v[84:85], v33 offset:1024
  ds_read_b128 v[86:89], v32 offset:1536
  ds_read_b64 v[90:91], v33 offset:2560
  s_waitcnt lgkmcnt(0)
  v_cmp_eq_u32 s[74:75], 1, v3
  s_nop 1
  v_cndmask_b32 v84, v84, 0, s[74:75]
  v_cndmask_b32 v85, v85, 0, s[74:75]
  v_cndmask_b32 v90, v90, 0, s[74:75]
  v_cndmask_b32 v91, v91, 0, s[74:75]
  v_mov_b32 v38, 0xff800000
  v_mov_b32 v39, 0xff800000
  s_mov_b32 s66, 65536
  s_mov_b32 s68, 64
FB1_loop:
  buffer_load_dwordx4 v[4:7], v1, s[8:11], s66 offen offset:0 sc1
  buffer_load_dwordx2 v[16:17], v2, s[8:11], s66 offen offset:3072 sc1
  buffer_load_dwordx4 v[8:11], v1, s[8:11], s66 offen offset:1024 sc1
  buffer_load_dwordx4 v[12:15], v1, s[8:11], s66 offen offset:2048 sc1
  s_add_u32 s66, s66, 3584
  s_waitcnt vmcnt(0)
  v_mfma_f32_32x32x16_bf16 v[48:63], v[4:7], v[80:83], 0
  v_mfma_f32_32x32x8_bf16 v[48:63], v[16:17], v[84:85], v[48:63]
  v_mfma_f32_32x32x16_bf16 v[64:79], v[4:7], v[86:89], 0
  v_mfma_f32_32x32x8_bf16 v[64:79], v[16:17], v[90:91], v[64:79]
  s_nop 15
  s_nop 7
  v_max3_f32 v38, v48, v49, v38
  v_max3_f32 v38, v50, v51, v38
  v_max3_f32 v38, v52, v53, v38
  v_max3_f32 v38, v54, v55, v38
  v_max3_f32 v38, v56, v57, v38
  v_max3_f32 v38, v58, v59, v38
  v_max3_f32 v38, v60, v61, v38
  v_max3_f32 v38, v62, v63, v38
  v_max3_f32 v39, v64, v65, v39
  v_max3_f32 v39, v66, v67, v39
  v_max3_f32 v39, v68, v69, v39
  v_max3_f32 v39, v70, v71, v39
  v_max3_f32 v39, v72, v73, v39
  v_max3_f32 v39, v74, v75, v39
  v_max3_f32 v39, v76, v77, v39
  v_max3_f32 v39, v78, v79, v39
  s_sub_u32 s68, s68, 1
  s_cmp_lg_u32 s68, 0
  s_cbranch_scc1 FB1_loop
  v_mov_b32 v32, v38
  s_nop 1
  v_permlane32_swap_b32 v32, v38
  s_nop 1
  v_max_f32 v32, v32, v38
  v_sub_f32 v32, 0, v32
  v_and_b32 v33, 0xffff0000, v32
  v_sub_f32 v32, v32, v33
  v_and_b32 v34, 0xffff0000, v32
  v_sub_f32 v32, v32, v34
  v_lshrrev_b32 v32, 16, v32
  v_lshrrev_b32 v33, 16, v33
  v_or_b32 v33, v33, v34
  v_cndmask_b32 v84, v84, v33, s[74:75]
  v_cndmask_b32 v85, v85, v32, s[74:75]
  v_mov_b32 v32, v39
  s_nop 1
  v_permlane32_swap_b32 v32, v39
  s_nop 1
  v_max_f32 v32, v32, v39
  v_sub_f32 v32, 0, v32
  v_and_b32 v33, 0xffff0000, v32
  v_sub_f32 v32, v32, v33
  v_and_b32 v34, 0xffff0000, v32
  v_sub_f32 v32, v32, v34
  v_lshrrev_b32 v32, 16, v32
  v_lshrrev_b32 v33, 16, v33
  v_or_b32 v33, v33, v34
  v_cndmask_b32 v90, v90, v33, s[74:75]
  v_cndmask_b32 v91, v91, v32, s[74:75]
  v_mov_b32 v224, 0
  v_mov_b32 v225, 0
  v_mov_b32 v226, 0
  v_mov_b32 v227, 0
  v_mov_b32 v228, 0
  v_mov_b32 v229, 0
  v_mov_b32 v230, 0
  v_mov_b32 v231, 0
  v_mov_b32 v232, 0
  v_mov_b32 v233, 0
  v_mov_b32 v234, 0
  v_mov_b32 v235, 0
  v_mov_b32 v236, 0
  v_mov_b32 v237, 0
  v_mov_b32 v238, 0
  v_mov_b32 v239, 0
  v_mov_b32 v240, 0
  v_mov_b32 v241, 0
  v_mov_b32 v242, 0
  v_mov_b32 v243, 0
  v_mov_b32 v244, 0
  v_mov_b32 v245, 0
  v_mov_b32 v246, 0
  v_mov_b32 v247, 0
  v_mov_b32 v248, 0
  v_mov_b32 v249, 0
  v_mov_b32 v250, 0
  v_mov_b32 v251, 0
  v_mov_b32 v252, 0
  v_mov_b32 v253, 0
  v_mov_b32 v254, 0
  v_mov_b32 v255, 0
  s_mov_b32 s66, 65536
  s_mov_b32 s68, 64
FB2_loop:
  buffer_load_dwordx4 v[4:7], v1, s[8:11], s66 offen offset:0 sc1
  buffer_load_dwordx2 v[16:17], v2, s[8:11], s66 offen offset:3072 sc1
  buffer_load_dwordx4 v[8:11], v1, s[8:11], s66 offen offset:1024 sc1
  buffer_load_dwordx4 v[12:15], v1, s[8:11], s66 offen offset:2048 sc1
  s_add_u32 s66, s66, 3584
  s_waitcnt vmcnt(0)
  v_mfma_f32_32x32x16_bf16 v[48:63], v[4:7], v[80:83], 0
  v_mfma_f32_32x32x8_bf16 v[48:63], v[16:17], v[84:85], v[48:63]
  v_mfma_f32_32x32x16_bf16 v[64:79], v[4:7], v[86:89], 0
  v_mfma_f32_32x32x8_bf16 v[64:79], v[16:17], v[90:91], v[64:79]
  s_nop 15
  s_nop 7
  v_exp_f32 v48, v48
  v_exp_f32 v49, v49
  v_exp_f32 v50, v50
  v_exp_f32 v51, v51
  v_exp_f32 v52, v52
  v_exp_f32 v53, v53
  v_exp_f32 v54, v54
  v_exp_f32 v55, v55
  v_exp_f32 v56, v56
  v_exp_f32 v57, v57
  v_exp_f32 v58, v58
  v_exp_f32 v59, v59
  v_exp_f32 v60, v60
  v_exp_f32 v61, v61
  v_exp_f32 v62, v62
  v_exp_f32 v63, v63
  v_exp_f32 v64, v64
  v_exp_f32 v65, v65
  v_exp_f32 v66, v66
  v_exp_f32 v67, v67
  v_exp_f32 v68, v68
  v_exp_f32 v69, v69
  v_exp_f32 v70, v70
  v_exp_f32 v71, v71
  v_exp_f32 v72, v72
  v_exp_f32 v73, v73
  v_exp_f32 v74, v74
  v_exp_f32 v75, v75
  v_exp_f32 v76, v76
  v_exp_f32 v77, v77
  v_exp_f32 v78, v78
  v_exp_f32 v79, v79
  s_nop 3
  v_smfmac_f32_32x32x32_bf16 v[224:239], v[8:11], v[48:55], v0
  v_smfmac_f32_32x32x32_bf16 v[224:239], v[12:15], v[56:63], v0
  v_smfmac_f32_32x32x32_bf16 v[240:255], v[8:11], v[64:71], v0
  v_smfmac_f32_32x32x32_bf16 v[240:255], v[12:15], v[72:79], v0
  s_nop 15
  s_sub_u32 s68, s68, 1
  s_cmp_lg_u32 s68, 0
  s_cbranch_scc1 FB2_loop
  s_nop 15
  s_branch L_norm
L_phase2B:
  s_mov_b32 s56, s99
  v_mov_b32 v120, 161820
  s_mov_b32 s57, 0
HC_spin:
  ds_read_b32 v122, v120
  s_waitcnt lgkmcnt(0)
  v_readfirstlane_b32 s60, v122
  s_nop 3
  s_cmp_ge_u32 s60, 4
  s_cbranch_scc1 HC_ok
  s_add_u32 s57, s57, 1
  s_cmp_ge_u32 s57, 4000000
  s_cbranch_scc1 HC_ok
  s_sleep 3
  s_branch HC_spin
HC_ok:
  s_mov_b32 s12, s36
  s_and_b32 s13, s37, 0xffff
  s_mov_b32 s14, 0x21c000
  s_mov_b32 s15, 0x00020000
  s_mul_i32 s77, s76, 552960
  s_mul_i32 s60, s48, 160
  s_add_u32 s77, s77, s60
  s_add_u32 m0, s56, 0
  s_nop 0
  buffer_load_dwordx4 v4, s[12:15], s77 offen lds
  s_add_u32 m0, m0, 1024
  s_nop 0
  buffer_load_dwordx4 v5, s[12:15], s77 offen lds
  s_add_u32 m0, m0, 1024
  s_nop 0
  buffer_load_dwordx4 v6, s[12:15], s77 offen lds
  s_add_u32 s77, s77, 20480
  s_add_u32 m0, s56, 3072
  s_nop 0
  buffer_load_dwordx4 v4, s[12:15], s77 offen lds
  s_add_u32 m0, m0, 1024
  s_nop 0
  buffer_load_dwordx4 v5, s[12:15], s77 offen lds
  s_add_u32 m0, m0, 1024
  s_nop 0
  buffer_load_dwordx4 v6, s[12:15], s77 offen lds
  s_add_u32 s77, s77, 20480
  s_add_u32 m0, s56, 6144
  s_nop 0
  buffer_load_dwordx4 v4, s[12:15], s77 offen lds
  s_add_u32 m0, m0, 1024
  s_nop 0
  buffer_load_dwordx4 v5, s[12:15], s77 offen lds
  s_add_u32 m0, m0, 1024
  s_nop 0
  buffer_load_dwordx4 v6, s[12:15], s77 offen lds
  s_add_u32 s77, s77, 20480
  s_add_u32 m0, s56, 9216
  s_nop 0
  buffer_load_dwordx4 v4, s[12:15], s77 offen lds
  s_add_u32 m0, m0, 1024
  s_nop 0
  buffer_load_dwordx4 v5, s[12:15], s77 offen lds
  s_add_u32 m0, m0, 1024
  s_nop 0
  buffer_load_dwordx4 v6, s[12:15], s77 offen lds
  s_add_u32 s77, s77, 20480
  s_add_u32 m0, s56, 12288
  s_nop 0
  buffer_load_dwordx4 v4, s[12:15], s77 offen lds
  s_add_u32 m0, m0, 1024
  s_nop 0
  buffer_load_dwordx4 v5, s[12:15], s77 offen lds
  s_add_u32 m0, m0, 1024
  s_nop 0
  buffer_load_dwordx4 v6, s[12:15], s77 offen lds
  s_add_u32 s77, s77, 20480
  s_cmp_lg_u32 s46, 7
  s_cbranch_scc1 L_hf_wait
  s_lshl_b32 s61, s47, 10
  s_add_u32 s61, s61, 0
  v_lshlrev_b32 v120, 7, v1
  s_mov_b64 s[72:73], exec
  s_mov_b64 exec, 255
  s_mov_b32 s57, 0
HF_poll:
  buffer_load_dwordx2 v[122:123], v120, s[8:11], s61 offen sc1
  s_waitcnt vmcnt(0)
  v_cmp_eq_u32 vcc, s50, v122
  s_nop 3
  s_cmp_eq_u64 vcc, exec
  s_cbranch_scc1 HF_ok
  s_add_u32 s57, s57, 1
  s_cmp_ge_u32 s57, 1000000
  s_cbranch_scc1 HF_to
  s_sleep 4
  s_branch HF_poll
HF_to:
HF_ok:
  s_mov_b64 exec, s[72:73]
  v_mov_b32 v120, 161832
  v_mov_b32 v121, 1
  ds_write_b32 v120, v121
L_hf_wait:
  v_mov_b32 v120, 161832
  s_mov_b32 s57, 0
HFR_spin:
  ds_read_b32 v122, v120
  s_waitcnt lgkmcnt(0)
  s_nop 0
  v_readfirstlane_b32 s60, v122
  s_nop 3
  s_cmp_lg_u32 s60, 0
  s_cbranch_scc1 HFR_ok
  s_add_u32 s57, s57, 1
  s_cmp_ge_u32 s57, 4000000
  s_cbranch_scc1 HFR_to
  s_sleep 3
  s_branch HFR_spin
HFR_to:
HFR_ok:
  s_setprio 3
  s_mul_i32 s78, s47, 221184
  s_mul_i32 s60, s76, 27648
  s_add_u32 s78, s78, s60
  s_add_u32 s78, s78, 524288
  s_add_u32 s79, s78, 110592
  s_add_u32 s96, s78, 26624
  s_add_u32 s97, s79, 26624
  buffer_load_dwordx4 v[16:19], v12, s[8:11], s78 offen sc1
  buffer_load_dwordx4 v[20:23], v12, s[8:11], s79 offen sc1
  s_add_u32 s78, s78, 1024
  s_add_u32 s79, s79, 1024
  s_min_u32 s78, s78, s96
  s_min_u32 s79, s79, s97
  buffer_load_dwordx4 v[24:27], v12, s[8:11], s78 offen sc1
  buffer_load_dwordx4 v[28:31], v12, s[8:11], s79 offen sc1
  s_add_u32 s78, s78, 1024
  s_add_u32 s79, s79, 1024
  s_min_u32 s78, s78, s96
  s_min_u32 s79, s79, s97
  buffer_load_dwordx4 v[32:35], v12, s[8:11], s78 offen sc1
  buffer_load_dwordx4 v[36:39], v12, s[8:11], s79 offen sc1
  s_add_u32 s78, s78, 1024
  s_add_u32 s79, s79, 1024
  s_min_u32 s78, s78, s96
  s_min_u32 s79, s79, s97
  buffer_load_dwordx4 v[40:43], v12, s[8:11], s78 offen sc1
  buffer_load_dwordx4 v[44:47], v12, s[8:11], s79 offen sc1
  s_add_u32 s78, s78, 1024
  s_add_u32 s79, s79, 1024
  s_min_u32 s78, s78, s96
  s_min_u32 s79, s79, s97
  buffer_load_dwordx4 v[48:51], v12, s[8:11], s78 offen sc1
  buffer_load_dwordx4 v[52:55], v12, s[8:11], s79 offen sc1
  s_add_u32 s78, s78, 1024
  s_add_u32 s79, s79, 1024
  s_min_u32 s78, s78, s96
  s_min_u32 s79, s79, s97
  buffer_load_dwordx4 v[56:59], v12, s[8:11], s78 offen sc1
  buffer_load_dwordx4 v[60:63], v12, s[8:11], s79 offen sc1
  s_add_u32 s78, s78, 1024
  s_add_u32 s79, s79, 1024
  s_min_u32 s78, s78, s96
  s_min_u32 s79, s79, s97
  buffer_load_dwordx4 v[64:67], v12, s[8:11], s78 offen sc1
  buffer_load_dwordx4 v[68:71], v12, s[8:11], s79 offen sc1
  s_add_u32 s78, s78, 1024
  s_add_u32 s79, s79, 1024
  s_min_u32 s78, s78, s96
  s_min_u32 s79, s79, s97
  buffer_load_dwordx4 v[72:75], v12, s[8:11], s78 offen sc1
  buffer_load_dwordx4 v[76:79], v12, s[8:11], s79 offen sc1
  s_add_u32 s78, s78, 1024
  s_add_u32 s79, s79, 1024
  s_min_u32 s78, s78, s96
  s_min_u32 s79, s79, s97
  buffer_load_dwordx4 v[80:83], v12, s[8:11], s78 offen sc1
  buffer_load_dwordx4 v[84:87], v12, s[8:11], s79 offen sc1
  s_add_u32 s78, s78, 1024
  s_add_u32 s79, s79, 1024
  s_min_u32 s78, s78, s96
  s_min_u32 s79, s79, s97
  s_waitcnt vmcnt(0)
  s_setprio 0
  v_mov_b32 v11, v10
  ds_read_b64_tr_b16 v[96:97], v11 offset:0
  ds_read_b64_tr_b16 v[98:99], v11 offset:1536
  ds_read_b64_tr_b16 v[100:101], v11 offset:64
  ds_read_b64_tr_b16 v[102:103], v11 offset:1600
  ds_read_b64_tr_b16 v[104:105], v11 offset:128
  ds_read_b64_tr_b16 v[106:107], v11 offset:1664
  s_mov_b32 s54, 3072
  s_mov_b32 s55, 0
  s_mov_b32 s68, 3
F2_loop:
  s_setprio 2
  v_add_u32 v11, s54, v10
  s_waitcnt vmcnt(9)
  ds_read_b64_tr_b16 v[108:109], v11 offset:0
  ds_read_b64_tr_b16 v[110:111], v11 offset:1536
  ds_read_b64_tr_b16 v[112:113], v11 offset:64
  ds_read_b64_tr_b16 v[114:115], v11 offset:1600
  ds_read_b64_tr_b16 v[116:117], v11 offset:128
  ds_read_b64_tr_b16 v[118:119], v11 offset:1664
  s_add_u32 s54, s54, 3072
  s_cmp_eq_u32 s54, 15360
  s_cselect_b32 s54, 0, s54
  s_add_u32 m0, s56, s55
  s_waitcnt lgkmcnt(6)
  v_mfma_f32_32x32x16_bf16 v[160:175], v[96:99], v[16:19], v[160:175]
  v_mfma_f32_32x32x16_bf16 v[176:191], v[96:99], v[20:23], v[176:191]
  v_mfma_f32_32x32x16_bf16 v[192:207], v[100:103], v[16:19], v[192:207]
  v_mfma_f32_32x32x16_bf16 v[208:223], v[100:103], v[20:23], v[208:223]
  v_mfma_f32_32x32x16_bf16 v[224:239], v[104:107], v[16:19], v[224:239]
  v_mfma_f32_32x32x16_bf16 v[240:255], v[104:107], v[20:23], v[240:255]
  buffer_load_dwordx4 v4, s[12:15], s77 offen lds
  s_add_u32 m0, m0, 1024
  s_nop 0
  buffer_load_dwordx4 v5, s[12:15], s77 offen lds
  s_add_u32 m0, m0, 1024
  s_nop 0
  buffer_load_dwordx4 v6, s[12:15], s77 offen lds
  s_add_u32 s77, s77, 20480
  buffer_load_dwordx4 v[16:19], v12, s[8:11], s78 offen sc1
  buffer_load_dwordx4 v[20:23], v12, s[8:11], s79 offen sc1
  s_add_u32 s78, s78, 1024
  s_add_u32 s79, s79, 1024
  s_min_u32 s78, s78, s96
  s_min_u32 s79, s79, s97
  s_add_u32 s55, s55, 3072
  s_cmp_eq_u32 s55, 15360
  s_cselect_b32 s55, 0, s55
  v_add_u32 v11, s54, v10
  s_waitcnt vmcnt(9)
  ds_read_b64_tr_b16 v[96:97], v11 offset:0
  ds_read_b64_tr_b16 v[98:99], v11 offset:1536
  ds_read_b64_tr_b16 v[100:101], v11 offset:64
  ds_read_b64_tr_b16 v[102:103], v11 offset:1600
  ds_read_b64_tr_b16 v[104:105], v11 offset:128
  ds_read_b64_tr_b16 v[106:107], v11 offset:1664
  s_add_u32 s54, s54, 3072
  s_cmp_eq_u32 s54, 15360
  s_cselect_b32 s54, 0, s54
  s_add_u32 m0, s56, s55
  s_waitcnt lgkmcnt(6)
  v_mfma_f32_32x32x16_bf16 v[160:175], v[108:111], v[24:27], v[160:175]
  v_mfma_f32_32x32x16_bf16 v[176:191], v[108:111], v[28:31], v[176:191]
  v_mfma_f32_32x32x16_bf16 v[192:207], v[112:115], v[24:27], v[192:207]
  v_mfma_f32_32x32x16_bf16 v[208:223], v[112:115], v[28:31], v[208:223]
  v_mfma_f32_32x32x16_bf16 v[224:239], v[116:119], v[24:27], v[224:239]
  v_mfma_f32_32x32x16_bf16 v[240:255], v[116:119], v[28:31], v[240:255]
  buffer_load_dwordx4 v4, s[12:15], s77 offen lds
  s_add_u32 m0, m0, 1024
  s_nop 0
  buffer_load_dwordx4 v5, s[12:15], s77 offen lds
  s_add_u32 m0, m0, 1024
  s_nop 0
  buffer_load_dwordx4 v6, s[12:15], s77 offen lds
  s_add_u32 s77, s77, 20480
  buffer_load_dwordx4 v[24:27], v12, s[8:11], s78 offen sc1
  buffer_load_dwordx4 v[28:31], v12, s[8:11], s79 offen sc1
  s_add_u32 s78, s78, 1024
  s_add_u32 s79, s79, 1024
  s_min_u32 s78, s78, s96
  s_min_u32 s79, s79, s97
  s_add_u32 s55, s55, 3072
  s_cmp_eq_u32 s55, 15360
  s_cselect_b32 s55, 0, s55
  v_add_u32 v11, s54, v10
  s_waitcnt vmcnt(9)
  ds_read_b64_tr_b16 v[108:109], v11 offset:0
  ds_read_b64_tr_b16 v[110:111], v11 offset:1536
  ds_read_b64_tr_b16 v[112:113], v11 offset:64
  ds_read_b64_tr_b16 v[114:115], v11 offset:1600
  ds_read_b64_tr_b16 v[116:117], v11 offset:128
  ds_read_b64_tr_b16 v[118:119], v11 offset:1664
  s_add_u32 s54, s54, 3072
  s_cmp_eq_u32 s54, 15360
  s_cselect_b32 s54, 0, s54
  s_add_u32 m0, s56, s55
  s_waitcnt lgkmcnt(6)
  v_mfma_f32_32x32x16_bf16 v[160:175], v[96:99], v[32:35], v[160:175]
  v_mfma_f32_32x32x16_bf16 v[176:191], v[96:99], v[36:39], v[176:191]
  v_mfma_f32_32x32x16_bf16 v[192:207], v[100:103], v[32:35], v[192:207]
  v_mfma_f32_32x32x16_bf16 v[208:223], v[100:103], v[36:39], v[208:223]
  v_mfma_f32_32x32x16_bf16 v[224:239], v[104:107], v[32:35], v[224:239]
  v_mfma_f32_32x32x16_bf16 v[240:255], v[104:107], v[36:39], v[240:255]
  buffer_load_dwordx4 v4, s[12:15], s77 offen lds
  s_add_u32 m0, m0, 1024
  s_nop 0
  buffer_load_dwordx4 v5, s[12:15], s77 offen lds
  s_add_u32 m0, m0, 1024
  s_nop 0
  buffer_load_dwordx4 v6, s[12:15], s77 offen lds
  s_add_u32 s77, s77, 20480
  buffer_load_dwordx4 v[32:35], v12, s[8:11], s78 offen sc1
  buffer_load_dwordx4 v[36:39], v12, s[8:11], s79 offen sc1
  s_add_u32 s78, s78, 1024
  s_add_u32 s79, s79, 1024
  s_min_u32 s78, s78, s96
  s_min_u32 s79, s79, s97
  s_add_u32 s55, s55, 3072
  s_cmp_eq_u32 s55, 15360
  s_cselect_b32 s55, 0, s55
  v_add_u32 v11, s54, v10
  s_waitcnt vmcnt(9)
  ds_read_b64_tr_b16 v[96:97], v11 offset:0
  ds_read_b64_tr_b16 v[98:99], v11 offset:1536
  ds_read_b64_tr_b16 v[100:101], v11 offset:64
  ds_read_b64_tr_b16 v[102:103], v11 offset:1600
  ds_read_b64_tr_b16 v[104:105], v11 offset:128
  ds_read_b64_tr_b16 v[106:107], v11 offset:1664
  s_add_u32 s54, s54, 3072
  s_cmp_eq_u32 s54, 15360
  s_cselect_b32 s54, 0, s54
  s_add_u32 m0, s56, s55
  s_waitcnt lgkmcnt(6)
  v_mfma_f32_32x32x16_bf16 v[160:175], v[108:111], v[40:43], v[160:175]
  v_mfma_f32_32x32x16_bf16 v[176:191], v[108:111], v[44:47], v[176:191]
  v_mfma_f32_32x32x16_bf16 v[192:207], v[112:115], v[40:43], v[192:207]
  v_mfma_f32_32x32x16_bf16 v[208:223], v[112:115], v[44:47], v[208:223]
  v_mfma_f32_32x32x16_bf16 v[224:239], v[116:119], v[40:43], v[224:239]
  v_mfma_f32_32x32x16_bf16 v[240:255], v[116:119], v[44:47], v[240:255]
  buffer_load_dwordx4 v4, s[12:15], s77 offen lds
  s_add_u32 m0, m0, 1024
  s_nop 0
  buffer_load_dwordx4 v5, s[12:15], s77 offen lds
  s_add_u32 m0, m0, 1024
  s_nop 0
  buffer_load_dwordx4 v6, s[12:15], s77 offen lds
  s_add_u32 s77, s77, 20480
  buffer_load_dwordx4 v[40:43], v12, s[8:11], s78 offen sc1
  buffer_load_dwordx4 v[44:47], v12, s[8:11], s79 offen sc1
  s_add_u32 s78, s78, 1024
  s_add_u32 s79, s79, 1024
  s_min_u32 s78, s78, s96
  s_min_u32 s79, s79, s97
  s_add_u32 s55, s55, 3072
  s_cmp_eq_u32 s55, 15360
  s_cselect_b32 s55, 0, s55
  v_add_u32 v11, s54, v10
  s_waitcnt vmcnt(9)
  ds_read_b64_tr_b16 v[108:109], v11 offset:0
  ds_read_b64_tr_b16 v[110:111], v11 offset:1536
  ds_read_b64_tr_b16 v[112:113], v11 offset:64
  ds_read_b64_tr_b16 v[114:115], v11 offset:1600
  ds_read_b64_tr_b16 v[116:117], v11 offset:128
  ds_read_b64_tr_b16 v[118:119], v11 offset:1664
  s_add_u32 s54, s54, 3072
  s_cmp_eq_u32 s54, 15360
  s_cselect_b32 s54, 0, s54
  s_add_u32 m0, s56, s55
  s_waitcnt lgkmcnt(6)
  v_mfma_f32_32x32x16_bf16 v[160:175], v[96:99], v[48:51], v[160:175]
  v_mfma_f32_32x32x16_bf16 v[176:191], v[96:99], v[52:55], v[176:191]
  v_mfma_f32_32x32x16_bf16 v[192:207], v[100:103], v[48:51], v[192:207]
  v_mfma_f32_32x32x16_bf16 v[208:223], v[100:103], v[52:55], v[208:223]
  v_mfma_f32_32x32x16_bf16 v[224:239], v[104:107], v[48:51], v[224:239]
  v_mfma_f32_32x32x16_bf16 v[240:255], v[104:107], v[52:55], v[240:255]
  buffer_load_dwordx4 v4, s[12:15], s77 offen lds
  s_add_u32 m0, m0, 1024
  s_nop 0
  buffer_load_dwordx4 v5, s[12:15], s77 offen lds
  s_add_u32 m0, m0, 1024
  s_nop 0
  buffer_load_dwordx4 v6, s[12:15], s77 offen lds
  s_add_u32 s77, s77, 20480
  buffer_load_dwordx4 v[48:51], v12, s[8:11], s78 offen sc1
  buffer_load_dwordx4 v[52:55], v12, s[8:11], s79 offen sc1
  s_add_u32 s78, s78, 1024
  s_add_u32 s79, s79, 1024
  s_min_u32 s78, s78, s96
  s_min_u32 s79, s79, s97
  s_add_u32 s55, s55, 3072
  s_cmp_eq_u32 s55, 15360
  s_cselect_b32 s55, 0, s55
  v_add_u32 v11, s54, v10
  s_waitcnt vmcnt(9)
  ds_read_b64_tr_b16 v[96:97], v11 offset:0
  ds_read_b64_tr_b16 v[98:99], v11 offset:1536
  ds_read_b64_tr_b16 v[100:101], v11 offset:64
  ds_read_b64_tr_b16 v[102:103], v11 offset:1600
  ds_read_b64_tr_b16 v[104:105], v11 offset:128
  ds_read_b64_tr_b16 v[106:107], v11 offset:1664
  s_add_u32 s54, s54, 3072
  s_cmp_eq_u32 s54, 15360
  s_cselect_b32 s54, 0, s54
  s_add_u32 m0, s56, s55
  s_waitcnt lgkmcnt(6)
  v_mfma_f32_32x32x16_bf16 v[160:175], v[108:111], v[56:59], v[160:175]
  v_mfma_f32_32x32x16_bf16 v[176:191], v[108:111], v[60:63], v[176:191]
  v_mfma_f32_32x32x16_bf16 v[192:207], v[112:115], v[56:59], v[192:207]
  v_mfma_f32_32x32x16_bf16 v[208:223], v[112:115], v[60:63], v[208:223]
  v_mfma_f32_32x32x16_bf16 v[224:239], v[116:119], v[56:59], v[224:239]
  v_mfma_f32_32x32x16_bf16 v[240:255], v[116:119], v[60:63], v[240:255]
  buffer_load_dwordx4 v4, s[12:15], s77 offen lds
  s_add_u32 m0, m0, 1024
  s_nop 0
  buffer_load_dwordx4 v5, s[12:15], s77 offen lds
  s_add_u32 m0, m0, 1024
  s_nop 0
  buffer_load_dwordx4 v6, s[12:15], s77 offen lds
  s_add_u32 s77, s77, 20480
  buffer_load_dwordx4 v[56:59], v12, s[8:11], s78 offen sc1
  buffer_load_dwordx4 v[60:63], v12, s[8:11], s79 offen sc1
  s_add_u32 s78, s78, 1024
  s_add_u32 s79, s79, 1024
  s_min_u32 s78, s78, s96
  s_min_u32 s79, s79, s97
  s_add_u32 s55, s55, 3072
  s_cmp_eq_u32 s55, 15360
  s_cselect_b32 s55, 0, s55
  s_setprio 0
  v_add_u32 v11, s54, v10
  s_waitcnt vmcnt(9)
  ds_read_b64_tr_b16 v[108:109], v11 offset:0
  ds_read_b64_tr_b16 v[110:111], v11 offset:1536
  ds_read_b64_tr_b16 v[112:113], v11 offset:64
  ds_read_b64_tr_b16 v[114:115], v11 offset:1600
  ds_read_b64_tr_b16 v[116:117], v11 offset:128
  ds_read_b64_tr_b16 v[118:119], v11 offset:1664
  s_add_u32 s54, s54, 3072
  s_cmp_eq_u32 s54, 15360
  s_cselect_b32 s54, 0, s54
  s_add_u32 m0, s56, s55
  s_waitcnt lgkmcnt(6)
  v_mfma_f32_32x32x16_bf16 v[160:175], v[96:99], v[64:67], v[160:175]
  v_mfma_f32_32x32x16_bf16 v[176:191], v[96:99], v[68:71], v[176:191]
  v_mfma_f32_32x32x16_bf16 v[192:207], v[100:103], v[64:67], v[192:207]
  v_mfma_f32_32x32x16_bf16 v[208:223], v[100:103], v[68:71], v[208:223]
  v_mfma_f32_32x32x16_bf16 v[224:239], v[104:107], v[64:67], v[224:239]
  v_mfma_f32_32x32x16_bf16 v[240:255], v[104:107], v[68:71], v[240:255]
  buffer_load_dwordx4 v4, s[12:15], s77 offen lds
  s_add_u32 m0, m0, 1024
  s_nop 0
  buffer_load_dwordx4 v5, s[12:15], s77 offen lds
  s_add_u32 m0, m0, 1024
  s_nop 0
  buffer_load_dwordx4 v6, s[12:15], s77 offen lds
  s_add_u32 s77, s77, 20480
  buffer_load_dwordx4 v[64:67], v12, s[8:11], s78 offen sc1
  buffer_load_dwordx4 v[68:71], v12, s[8:11], s79 offen sc1
  s_add_u32 s78, s78, 1024
  s_add_u32 s79, s79, 1024
  s_min_u32 s78, s78, s96
  s_min_u32 s79, s79, s97
  s_add_u32 s55, s55, 3072
  s_cmp_eq_u32 s55, 15360
  s_cselect_b32 s55, 0, s55
  v_add_u32 v11, s54, v10
  s_waitcnt vmcnt(9)
  ds_read_b64_tr_b16 v[96:97], v11 offset:0
  ds_read_b64_tr_b16 v[98:99], v11 offset:1536
  ds_read_b64_tr_b16 v[100:101], v11 offset:64
  ds_read_b64_tr_b16 v[102:103], v11 offset:1600
  ds_read_b64_tr_b16 v[104:105], v11 offset:128
  ds_read_b64_tr_b16 v[106:107], v11 offset:1664
  s_add_u32 s54, s54, 3072
  s_cmp_eq_u32 s54, 15360
  s_cselect_b32 s54, 0, s54
  s_add_u32 m0, s56, s55
  s_waitcnt lgkmcnt(6)
  v_mfma_f32_32x32x16_bf16 v[160:175], v[108:111], v[72:75], v[160:175]
  v_mfma_f32_32x32x16_bf16 v[176:191], v[108:111], v[76:79], v[176:191]
  v_mfma_f32_32x32x16_bf16 v[192:207], v[112:115], v[72:75], v[192:207]
  v_mfma_f32_32x32x16_bf16 v[208:223], v[112:115], v[76:79], v[208:223]
  v_mfma_f32_32x32x16_bf16 v[224:239], v[116:119], v[72:75], v[224:239]
  v_mfma_f32_32x32x16_bf16 v[240:255], v[116:119], v[76:79], v[240:255]
  buffer_load_dwordx4 v4, s[12:15], s77 offen lds
  s_add_u32 m0, m0, 1024
  s_nop 0
  buffer_load_dwordx4 v5, s[12:15], s77 offen lds
  s_add_u32 m0, m0, 1024
  s_nop 0
  buffer_load_dwordx4 v6, s[12:15], s77 offen lds
  s_add_u32 s77, s77, 20480
  buffer_load_dwordx4 v[72:75], v12, s[8:11], s78 offen sc1
  buffer_load_dwordx4 v[76:79], v12, s[8:11], s79 offen sc1
  s_add_u32 s78, s78, 1024
  s_add_u32 s79, s79, 1024
  s_min_u32 s78, s78, s96
  s_min_u32 s79, s79, s97
  s_add_u32 s55, s55, 3072
  s_cmp_eq_u32 s55, 15360
  s_cselect_b32 s55, 0, s55
  v_add_u32 v11, s54, v10
  s_waitcnt vmcnt(9)
  ds_read_b64_tr_b16 v[108:109], v11 offset:0
  ds_read_b64_tr_b16 v[110:111], v11 offset:1536
  ds_read_b64_tr_b16 v[112:113], v11 offset:64
  ds_read_b64_tr_b16 v[114:115], v11 offset:1600
  ds_read_b64_tr_b16 v[116:117], v11 offset:128
  ds_read_b64_tr_b16 v[118:119], v11 offset:1664
  s_add_u32 s54, s54, 3072
  s_cmp_eq_u32 s54, 15360
  s_cselect_b32 s54, 0, s54
  s_add_u32 m0, s56, s55
  s_waitcnt lgkmcnt(6)
  v_mfma_f32_32x32x16_bf16 v[160:175], v[96:99], v[80:83], v[160:175]
  v_mfma_f32_32x32x16_bf16 v[176:191], v[96:99], v[84:87], v[176:191]
  v_mfma_f32_32x32x16_bf16 v[192:207], v[100:103], v[80:83], v[192:207]
  v_mfma_f32_32x32x16_bf16 v[208:223], v[100:103], v[84:87], v[208:223]
  v_mfma_f32_32x32x16_bf16 v[224:239], v[104:107], v[80:83], v[224:239]
  v_mfma_f32_32x32x16_bf16 v[240:255], v[104:107], v[84:87], v[240:255]
  buffer_load_dwordx4 v4, s[12:15], s77 offen lds
  s_add_u32 m0, m0, 1024
  s_nop 0
  buffer_load_dwordx4 v5, s[12:15], s77 offen lds
  s_add_u32 m0, m0, 1024
  s_nop 0
  buffer_load_dwordx4 v6, s[12:15], s77 offen lds
  s_add_u32 s77, s77, 20480
  buffer_load_dwordx4 v[80:83], v12, s[8:11], s78 offen sc1
  buffer_load_dwordx4 v[84:87], v12, s[8:11], s79 offen sc1
  s_add_u32 s78, s78, 1024
  s_add_u32 s79, s79, 1024
  s_min_u32 s78, s78, s96
  s_min_u32 s79, s79, s97
  s_add_u32 s55, s55, 3072
  s_cmp_eq_u32 s55, 15360
  s_cselect_b32 s55, 0, s55
  s_waitcnt lgkmcnt(0)
  v_mov_b32 v96, v108
  v_mov_b32 v97, v109
  v_mov_b32 v98, v110
  v_mov_b32 v99, v111
  v_mov_b32 v100, v112
  v_mov_b32 v101, v113
  v_mov_b32 v102, v114
  v_mov_b32 v103, v115
  v_mov_b32 v104, v116
  v_mov_b32 v105, v117
  v_mov_b32 v106, v118
  v_mov_b32 v107, v119
  s_sub_u32 s68, s68, 1
  s_cmp_lg_u32 s68, 0
  s_cbranch_scc1 F2_loop
  s_setprio 2
  s_waitcnt vmcnt(0) lgkmcnt(0)
  s_mov_b32 s12, s28
  s_and_b32 s13, s29, 0xffff
  s_mov_b32 s14, 0xc8000
  s_mov_b32 s15, 0x00020000
  s_mul_i32 s77, s76, 102400
  s_mul_i32 s60, s48, 160
  s_add_u32 s77, s77, s60
  s_add_u32 s60, s77, 0
  s_add_u32 m0, s56, 0
  s_nop 0
  buffer_load_dwordx4 v4, s[12:15], s60 offen lds
  s_add_u32 m0, m0, 1024
  s_nop 0
  buffer_load_dwordx4 v5, s[12:15], s60 offen lds
  s_add_u32 m0, m0, 1024
  s_nop 0
  buffer_load_dwordx4 v6, s[12:15], s60 offen lds
  s_add_u32 s60, s77, 25600
  s_add_u32 m0, s56, 3072
  s_nop 0
  buffer_load_dwordx4 v4, s[12:15], s60 offen lds
  s_add_u32 m0, m0, 1024
  s_nop 0
  buffer_load_dwordx4 v5, s[12:15], s60 offen lds
  s_add_u32 m0, m0, 1024
  s_nop 0
  buffer_load_dwordx4 v6, s[12:15], s60 offen lds
  s_add_u32 s60, s77, 51200
  s_add_u32 m0, s56, 6144
  s_nop 0
  buffer_load_dwordx4 v4, s[12:15], s60 offen lds
  s_add_u32 m0, m0, 1024
  s_nop 0
  buffer_load_dwordx4 v5, s[12:15], s60 offen lds
  s_add_u32 m0, m0, 1024
  s_nop 0
  buffer_load_dwordx4 v6, s[12:15], s60 offen lds
  s_add_u32 s60, s77, 76800
  s_add_u32 m0, s56, 9216
  s_nop 0
  buffer_load_dwordx4 v4, s[12:15], s60 offen lds
  s_add_u32 m0, m0, 1024
  s_nop 0
  buffer_load_dwordx4 v5, s[12:15], s60 offen lds
  s_add_u32 m0, m0, 1024
  s_nop 0
  buffer_load_dwordx4 v6, s[12:15], s60 offen lds
  s_add_u32 s60, s77, 0
  s_add_u32 m0, s56, 12288
  s_nop 0
  buffer_load_dwordx4 v7, s[12:15], s60 offen lds
  s_add_u32 m0, m0, 1024
  s_nop 0
  buffer_load_dwordx4 v8, s[12:15], s60 offen lds
  s_add_u32 m0, m0, 1024
  s_nop 0
  buffer_load_dwordx4 v9, s[12:15], s60 offen lds
  s_waitcnt vmcnt(0)
  v_add_u32 v11, 0, v10
  ds_read_b64_tr_b16 v[96:97], v11 offset:0
  ds_read_b64_tr_b16 v[98:99], v11 offset:1536
  ds_read_b64_tr_b16 v[100:101], v11 offset:64
  ds_read_b64_tr_b16 v[102:103], v11 offset:1600
  ds_read_b64_tr_b16 v[104:105], v11 offset:128
  ds_read_b64_tr_b16 v[106:107], v11 offset:1664
  v_add_u32 v11, 3072, v10
  ds_read_b64_tr_b16 v[108:109], v11 offset:0
  ds_read_b64_tr_b16 v[110:111], v11 offset:1536
  ds_read_b64_tr_b16 v[112:113], v11 offset:64
  ds_read_b64_tr_b16 v[114:115], v11 offset:1600
  ds_read_b64_tr_b16 v[116:117], v11 offset:128
  ds_read_b64_tr_b16 v[118:119], v11 offset:1664
  v_add_u32 v11, 6144, v10
  ds_read_b64_tr_b16 v[120:121], v11 offset:0
  ds_read_b64_tr_b16 v[122:123], v11 offset:1536
  ds_read_b64_tr_b16 v[124:125], v11 offset:64
  ds_read_b64_tr_b16 v[126:127], v11 offset:1600
  ds_read_b64_tr_b16 v[128:129], v11 offset:128
  ds_read_b64_tr_b16 v[130:131], v11 offset:1664
  v_add_u32 v11, 9216, v10
  ds_read_b64_tr_b16 v[132:133], v11 offset:0
  ds_read_b64_tr_b16 v[134:135], v11 offset:1536
  ds_read_b64_tr_b16 v[136:137], v11 offset:64
  ds_read_b64_tr_b16 v[138:139], v11 offset:1600
  ds_read_b64_tr_b16 v[140:141], v11 offset:128
  ds_read_b64_tr_b16 v[142:143], v11 offset:1664
  v_add_u32 v11, 12288, v10
  ds_read_b64_tr_b16 v[144:145], v11 offset:0
  ds_read_b64_tr_b16 v[146:147], v11 offset:1536
  ds_read_b64_tr_b16 v[148:149], v11 offset:64
  ds_read_b64_tr_b16 v[150:151], v11 offset:1600
  ds_read_b64_tr_b16 v[152:153], v11 offset:128
  ds_read_b64_tr_b16 v[154:155], v11 offset:1664
  s_waitcnt lgkmcnt(0)
  s_add_u32 s60, s77, 409600
  s_add_u32 m0, s56, 0
  s_nop 0
  buffer_load_dwordx4 v4, s[12:15], s60 offen lds
  s_add_u32 m0, m0, 1024
  s_nop 0
  buffer_load_dwordx4 v5, s[12:15], s60 offen lds
  s_add_u32 m0, m0, 1024
  s_nop 0
  buffer_load_dwordx4 v6, s[12:15], s60 offen lds
  s_add_u32 s60, s77, 435200
  s_add_u32 m0, s56, 3072
  s_nop 0
  buffer_load_dwordx4 v4, s[12:15], s60 offen lds
  s_add_u32 m0, m0, 1024
  s_nop 0
  buffer_load_dwordx4 v5, s[12:15], s60 offen lds
  s_add_u32 m0, m0, 1024
  s_nop 0
  buffer_load_dwordx4 v6, s[12:15], s60 offen lds
  s_add_u32 s60, s77, 460800
  s_add_u32 m0, s56, 6144
  s_nop 0
  buffer_load_dwordx4 v4, s[12:15], s60 offen lds
  s_add_u32 m0, m0, 1024
  s_nop 0
  buffer_load_dwordx4 v5, s[12:15], s60 offen lds
  s_add_u32 m0, m0, 1024
  s_nop 0
  buffer_load_dwordx4 v6, s[12:15], s60 offen lds
  s_add_u32 s60, s77, 486400
  s_add_u32 m0, s56, 9216
  s_nop 0
  buffer_load_dwordx4 v4, s[12:15], s60 offen lds
  s_add_u32 m0, m0, 1024
  s_nop 0
  buffer_load_dwordx4 v5, s[12:15], s60 offen lds
  s_add_u32 m0, m0, 1024
  s_nop 0
  buffer_load_dwordx4 v6, s[12:15], s60 offen lds
  s_add_u32 s60, s77, 409600
  s_add_u32 m0, s56, 12288
  s_nop 0
  buffer_load_dwordx4 v7, s[12:15], s60 offen lds
  s_add_u32 m0, m0, 1024
  s_nop 0
  buffer_load_dwordx4 v8, s[12:15], s60 offen lds
  s_add_u32 m0, m0, 1024
  s_nop 0
  buffer_load_dwordx4 v9, s[12:15], s60 offen lds
  s_waitcnt vmcnt(0)
  v_lshlrev_b32 v159, 9, v2
  v_lshl_add_u32 v159, v3, 3, v159
  v_mov_b32 v15, v159
  s_lshl_b32 s61, s47, 3
  s_add_u32 s61, s61, s76
  s_mul_i32 s77, s61, 10240
  s_add_u32 s77, s77, 8388608
  s_lshl_b32 s61, s61, 7
  s_add_u32 s61, s61, 32768
  v_lshlrev_b32 v156, 7, v1
  s_mov_b64 s[72:73], exec
  s_mov_b64 exec, 1
  s_mov_b32 s57, 0
OF0_poll:
  buffer_load_dwordx2 v[158:159], v156, s[8:11], s61 offen sc1
  s_waitcnt vmcnt(0)
  v_cmp_eq_u32 vcc, s50, v158
  s_nop 3
  s_cmp_eq_u64 vcc, exec
  s_cbranch_scc1 OF0_ok
  s_add_u32 s57, s57, 1
  s_cmp_ge_u32 s57, 1000000
  s_cbranch_scc1 OF0_to
  s_sleep 1
  s_branch OF0_poll
OF0_to:
OF0_ok:
  s_mov_b64 exec, s[72:73]
  s_add_u32 s61, s77, 0
  buffer_load_dwordx4 v[16:19], v12, s[8:11], s61 offen sc1
  s_add_u32 s61, s77, 5120
  buffer_load_dwordx4 v[20:23], v12, s[8:11], s61 offen sc1
  s_add_u32 s61, s77, 1024
  buffer_load_dwordx4 v[24:27], v12, s[8:11], s61 offen sc1
  s_add_u32 s61, s77, 6144
  buffer_load_dwordx4 v[28:31], v12, s[8:11], s61 offen sc1
  s_add_u32 s61, s77, 2048
  buffer_load_dwordx4 v[32:35], v12, s[8:11], s61 offen sc1
  s_add_u32 s61, s77, 7168
  buffer_load_dwordx4 v[36:39], v12, s[8:11], s61 offen sc1
  s_add_u32 s61, s77, 3072
  buffer_load_dwordx4 v[40:43], v12, s[8:11], s61 offen sc1
  s_add_u32 s61, s77, 8192
  buffer_load_dwordx4 v[44:47], v12, s[8:11], s61 offen sc1
  s_add_u32 s61, s77, 4096
  buffer_load_dwordx2 v[48:49], v15, s[8:11], s61 offen sc1
  buffer_load_dwordx2 v[50:51], v15, s[8:11], s61 offen offset:256 sc1
  s_add_u32 s61, s77, 9216
  buffer_load_dwordx2 v[52:53], v15, s[8:11], s61 offen sc1
  buffer_load_dwordx2 v[54:55], v15, s[8:11], s61 offen offset:256 sc1
  s_waitcnt vmcnt(10)
  v_mfma_f32_32x32x16_bf16 v[160:175], v[96:99], v[16:19], v[160:175]
  v_mfma_f32_32x32x16_bf16 v[176:191], v[96:99], v[20:23], v[176:191]
  v_mfma_f32_32x32x16_bf16 v[192:207], v[100:103], v[16:19], v[192:207]
  v_mfma_f32_32x32x16_bf16 v[208:223], v[100:103], v[20:23], v[208:223]
  v_mfma_f32_32x32x16_bf16 v[224:239], v[104:107], v[16:19], v[224:239]
  v_mfma_f32_32x32x16_bf16 v[240:255], v[104:107], v[20:23], v[240:255]
  v_add_u32 v11, 0, v10
  ds_read_b64_tr_b16 v[96:97], v11 offset:0
  ds_read_b64_tr_b16 v[98:99], v11 offset:1536
  ds_read_b64_tr_b16 v[100:101], v11 offset:64
  ds_read_b64_tr_b16 v[102:103], v11 offset:1600
  ds_read_b64_tr_b16 v[104:105], v11 offset:128
  ds_read_b64_tr_b16 v[106:107], v11 offset:1664
  s_waitcnt vmcnt(8)
  v_mfma_f32_32x32x16_bf16 v[160:175], v[108:111], v[24:27], v[160:175]
  v_mfma_f32_32x32x16_bf16 v[176:191], v[108:111], v[28:31], v[176:191]
  v_mfma_f32_32x32x16_bf16 v[192:207], v[112:115], v[24:27], v[192:207]
  v_mfma_f32_32x32x16_bf16 v[208:223], v[112:115], v[28:31], v[208:223]
  v_mfma_f32_32x32x16_bf16 v[224:239], v[116:119], v[24:27], v[224:239]
  v_mfma_f32_32x32x16_bf16 v[240:255], v[116:119], v[28:31], v[240:255]
  v_add_u32 v11, 3072, v10
  ds_read_b64_tr_b16 v[108:109], v11 offset:0
  ds_read_b64_tr_b16 v[110:111], v11 offset:1536
  ds_read_b64_tr_b16 v[112:113], v11 offset:64
  ds_read_b64_tr_b16 v[114:115], v11 offset:1600
  ds_read_b64_tr_b16 v[116:117], v11 offset:128
  ds_read_b64_tr_b16 v[118:119], v11 offset:1664
  s_waitcnt vmcnt(6)
  v_mfma_f32_32x32x16_bf16 v[160:175], v[120:123], v[32:35], v[160:175]
  v_mfma_f32_32x32x16_bf16 v[176:191], v[120:123], v[36:39], v[176:191]
  v_mfma_f32_32x32x16_bf16 v[192:207], v[124:127], v[32:35], v[192:207]
  v_mfma_f32_32x32x16_bf16 v[208:223], v[124:127], v[36:39], v[208:223]
  v_mfma_f32_32x32x16_bf16 v[224:239], v[128:131], v[32:35], v[224:239]
  v_mfma_f32_32x32x16_bf16 v[240:255], v[128:131], v[36:39], v[240:255]
  v_add_u32 v11, 6144, v10
  ds_read_b64_tr_b16 v[120:121], v11 offset:0
  ds_read_b64_tr_b16 v[122:123], v11 offset:1536
  ds_read_b64_tr_b16 v[124:125], v11 offset:64
  ds_read_b64_tr_b16 v[126:127], v11 offset:1600
  ds_read_b64_tr_b16 v[128:129], v11 offset:128
  ds_read_b64_tr_b16 v[130:131], v11 offset:1664
  s_waitcnt vmcnt(4)
  v_mfma_f32_32x32x16_bf16 v[160:175], v[132:135], v[40:43], v[160:175]
  v_mfma_f32_32x32x16_bf16 v[176:191], v[132:135], v[44:47], v[176:191]
  v_mfma_f32_32x32x16_bf16 v[192:207], v[136:139], v[40:43], v[192:207]
  v_mfma_f32_32x32x16_bf16 v[208:223], v[136:139], v[44:47], v[208:223]
  v_mfma_f32_32x32x16_bf16 v[224:239], v[140:143], v[40:43], v[224:239]
  v_mfma_f32_32x32x16_bf16 v[240:255], v[140:143], v[44:47], v[240:255]
  v_add_u32 v11, 9216, v10
  ds_read_b64_tr_b16 v[132:133], v11 offset:0
  ds_read_b64_tr_b16 v[134:135], v11 offset:1536
  ds_read_b64_tr_b16 v[136:137], v11 offset:64
  ds_read_b64_tr_b16 v[138:139], v11 offset:1600
  ds_read_b64_tr_b16 v[140:141], v11 offset:128
  ds_read_b64_tr_b16 v[142:143], v11 offset:1664
  s_waitcnt vmcnt(0)
  v_mfma_f32_32x32x16_bf16 v[160:175], v[144:147], v[48:51], v[160:175]
  v_mfma_f32_32x32x16_bf16 v[176:191], v[144:147], v[52:55], v[176:191]
  v_mfma_f32_32x32x16_bf16 v[192:207], v[148:151], v[48:51], v[192:207]
  v_mfma_f32_32x32x16_bf16 v[208:223], v[148:151], v[52:55], v[208:223]
  v_mfma_f32_32x32x16_bf16 v[224:239], v[152:155], v[48:51], v[224:239]
  v_mfma_f32_32x32x16_bf16 v[240:255], v[152:155], v[52:55], v[240:255]
  v_add_u32 v11, 12288, v10
  ds_read_b64_tr_b16 v[144:145], v11 offset:0
  ds_read_b64_tr_b16 v[146:147], v11 offset:1536
  ds_read_b64_tr_b16 v[148:149], v11 offset:64
  ds_read_b64_tr_b16 v[150:151], v11 offset:1600
  ds_read_b64_tr_b16 v[152:153], v11 offset:128
  ds_read_b64_tr_b16 v[154:155], v11 offset:1664
  s_lshl_b32 s61, s47, 3
  s_add_u32 s61, s61, s76
  s_add_u32 s61, s61, 4
  s_mul_i32 s77, s61, 10240
  s_add_u32 s77, s77, 8388608
  s_lshl_b32 s61, s61, 7
  s_add_u32 s61, s61, 32768
  v_lshlrev_b32 v156, 7, v1
  s_mov_b64 s[72:73], exec
  s_mov_b64 exec, 1
  s_mov_b32 s57, 0
OF1_poll:
  buffer_load_dwordx2 v[158:159], v156, s[8:11], s61 offen sc1
  s_waitcnt vmcnt(0)
  v_cmp_eq_u32 vcc, s50, v158
  s_nop 3
  s_cmp_eq_u64 vcc, exec
  s_cbranch_scc1 OF1_ok
  s_add_u32 s57, s57, 1
  s_cmp_ge_u32 s57, 1000000
  s_cbranch_scc1 OF1_to
  s_sleep 1
  s_branch OF1_poll
OF1_to:
OF1_ok:
  s_mov_b64 exec, s[72:73]
  s_add_u32 s61, s77, 0
  buffer_load_dwordx4 v[56:59], v12, s[8:11], s61 offen sc1
  s_add_u32 s61, s77, 5120
  buffer_load_dwordx4 v[60:63], v12, s[8:11], s61 offen sc1
  s_add_u32 s61, s77, 1024
  buffer_load_dwordx4 v[64:67], v12, s[8:11], s61 offen sc1
  s_add_u32 s61, s77, 6144
  buffer_load_dwordx4 v[68:71], v12, s[8:11], s61 offen sc1
  s_add_u32 s61, s77, 2048
  buffer_load_dwordx4 v[72:75], v12, s[8:11], s61 offen sc1
  s_add_u32 s61, s77, 7168
  buffer_load_dwordx4 v[76:79], v12, s[8:11], s61 offen sc1
  s_add_u32 s61, s77, 3072
  buffer_load_dwordx4 v[80:83], v12, s[8:11], s61 offen sc1
  s_add_u32 s61, s77, 8192
  buffer_load_dwordx4 v[84:87], v12, s[8:11], s61 offen sc1
  s_add_u32 s61, s77, 4096
  buffer_load_dwordx2 v[88:89], v15, s[8:11], s61 offen sc1
  buffer_load_dwordx2 v[90:91], v15, s[8:11], s61 offen offset:256 sc1
  s_add_u32 s61, s77, 9216
  buffer_load_dwordx2 v[92:93], v15, s[8:11], s61 offen sc1
  buffer_load_dwordx2 v[94:95], v15, s[8:11], s61 offen offset:256 sc1
  s_waitcnt vmcnt(10)
  s_waitcnt lgkmcnt(0)
  v_mfma_f32_32x32x16_bf16 v[160:175], v[96:99], v[56:59], v[160:175]
  v_mfma_f32_32x32x16_bf16 v[176:191], v[96:99], v[60:63], v[176:191]
  v_mfma_f32_32x32x16_bf16 v[192:207], v[100:103], v[56:59], v[192:207]
  v_mfma_f32_32x32x16_bf16 v[208:223], v[100:103], v[60:63], v[208:223]
  v_mfma_f32_32x32x16_bf16 v[224:239], v[104:107], v[56:59], v[224:239]
  v_mfma_f32_32x32x16_bf16 v[240:255], v[104:107], v[60:63], v[240:255]
  s_waitcnt vmcnt(8)
  v_mfma_f32_32x32x16_bf16 v[160:175], v[108:111], v[64:67], v[160:175]
  v_mfma_f32_32x32x16_bf16 v[176:191], v[108:111], v[68:71], v[176:191]
  v_mfma_f32_32x32x16_bf16 v[192:207], v[112:115], v[64:67], v[192:207]
  v_mfma_f32_32x32x16_bf16 v[208:223], v[112:115], v[68:71], v[208:223]
  v_mfma_f32_32x32x16_bf16 v[224:239], v[116:119], v[64:67], v[224:239]
  v_mfma_f32_32x32x16_bf16 v[240:255], v[116:119], v[68:71], v[240:255]
  s_waitcnt vmcnt(6)
  v_mfma_f32_32x32x16_bf16 v[160:175], v[120:123], v[72:75], v[160:175]
  v_mfma_f32_32x32x16_bf16 v[176:191], v[120:123], v[76:79], v[176:191]
  v_mfma_f32_32x32x16_bf16 v[192:207], v[124:127], v[72:75], v[192:207]
  v_mfma_f32_32x32x16_bf16 v[208:223], v[124:127], v[76:79], v[208:223]
  v_mfma_f32_32x32x16_bf16 v[224:239], v[128:131], v[72:75], v[224:239]
  v_mfma_f32_32x32x16_bf16 v[240:255], v[128:131], v[76:79], v[240:255]
  s_waitcnt vmcnt(4)
  v_mfma_f32_32x32x16_bf16 v[160:175], v[132:135], v[80:83], v[160:175]
  v_mfma_f32_32x32x16_bf16 v[176:191], v[132:135], v[84:87], v[176:191]
  v_mfma_f32_32x32x16_bf16 v[192:207], v[136:139], v[80:83], v[192:207]
  v_mfma_f32_32x32x16_bf16 v[208:223], v[136:139], v[84:87], v[208:223]
  v_mfma_f32_32x32x16_bf16 v[224:239], v[140:143], v[80:83], v[224:239]
  v_mfma_f32_32x32x16_bf16 v[240:255], v[140:143], v[84:87], v[240:255]
  s_waitcnt vmcnt(0)
  v_mfma_f32_32x32x16_bf16 v[160:175], v[144:147], v[88:91], v[160:175]
  v_mfma_f32_32x32x16_bf16 v[176:191], v[144:147], v[92:95], v[176:191]
  v_mfma_f32_32x32x16_bf16 v[192:207], v[148:151], v[88:91], v[192:207]
  v_mfma_f32_32x32x16_bf16 v[208:223], v[148:151], v[92:95], v[208:223]
  v_mfma_f32_32x32x16_bf16 v[224:239], v[152:155], v[88:91], v[224:239]
  v_mfma_f32_32x32x16_bf16 v[240:255], v[152:155], v[92:95], v[240:255]
  s_nop 15
  s_barrier
  s_mul_i32 s60, s76, 20480
  v_add_u32 v11, s60, v12
  ds_write_b128 v11, v[160:163] offset:0
  ds_write_b128 v11, v[164:167] offset:1024
  ds_write_b128 v11, v[168:171] offset:2048
  ds_write_b128 v11, v[172:175] offset:3072
  ds_write_b128 v11, v[224:227] offset:4096
  ds_write_b128 v11, v[192:195] offset:5120
  ds_write_b128 v11, v[196:199] offset:6144
  ds_write_b128 v11, v[200:203] offset:7168
  ds_write_b128 v11, v[204:207] offset:8192
  ds_write_b128 v11, v[228:231] offset:9216
  ds_write_b128 v11, v[176:179] offset:10240
  ds_write_b128 v11, v[180:183] offset:11264
  ds_write_b128 v11, v[184:187] offset:12288
  ds_write_b128 v11, v[188:191] offset:13312
  ds_write_b128 v11, v[240:243] offset:14336
  ds_write_b128 v11, v[208:211] offset:15360
  ds_write_b128 v11, v[212:215] offset:16384
  ds_write_b128 v11, v[216:219] offset:17408
  ds_write_b128 v11, v[220:223] offset:18432
  ds_write_b128 v11, v[244:247] offset:19456
  s_waitcnt lgkmcnt(0)
  s_barrier
  s_mul_i32 s60, s76, 5120
  v_add_u32 v11, s60, v12
  v_add_u32 v10, 61440, v11
  ds_read_b128 v[16:19], v11 offset:0
  ds_read_b128 v[20:23], v11 offset:1024
  ds_read_b128 v[24:27], v11 offset:2048
  ds_read_b128 v[28:31], v11 offset:3072
  ds_read_b128 v[32:35], v11 offset:4096
  ds_read_b128 v[36:39], v11 offset:20480
  ds_read_b128 v[40:43], v11 offset:21504
  ds_read_b128 v[44:47], v11 offset:22528
  ds_read_b128 v[48:51], v11 offset:23552
  ds_read_b128 v[52:55], v11 offset:24576
  ds_read_b128 v[56:59], v11 offset:40960
  ds_read_b128 v[60:63], v11 offset:41984
  ds_read_b128 v[64:67], v11 offset:43008
  ds_read_b128 v[68:71], v11 offset:44032
  ds_read_b128 v[72:75], v11 offset:45056
  ds_read_b128 v[76:79], v10 offset:0
  ds_read_b128 v[80:83], v10 offset:1024
  ds_read_b128 v[84:87], v10 offset:2048
  ds_read_b128 v[88:91], v10 offset:3072
  ds_read_b128 v[92:95], v10 offset:4096
  s_waitcnt lgkmcnt(0)
  v_pk_add_f32 v[16:17], v[16:17], v[36:37]
  v_pk_add_f32 v[56:57], v[56:57], v[76:77]
  v_pk_add_f32 v[16:17], v[16:17], v[56:57]
  v_pk_add_f32 v[18:19], v[18:19], v[38:39]
  v_pk_add_f32 v[58:59], v[58:59], v[78:79]
  v_pk_add_f32 v[18:19], v[18:19], v[58:59]
  v_pk_add_f32 v[20:21], v[20:21], v[40:41]
  v_pk_add_f32 v[60:61], v[60:61], v[80:81]
  v_pk_add_f32 v[20:21], v[20:21], v[60:61]
  v_pk_add_f32 v[22:23], v[22:23], v[42:43]
  v_pk_add_f32 v[62:63], v[62:63], v[82:83]
  v_pk_add_f32 v[22:23], v[22:23], v[62:63]
  v_pk_add_f32 v[24:25], v[24:25], v[44:45]
  v_pk_add_f32 v[64:65], v[64:65], v[84:85]
  v_pk_add_f32 v[24:25], v[24:25], v[64:65]
  v_pk_add_f32 v[26:27], v[26:27], v[46:47]
  v_pk_add_f32 v[66:67], v[66:67], v[86:87]
  v_pk_add_f32 v[26:27], v[26:27], v[66:67]
  v_pk_add_f32 v[28:29], v[28:29], v[48:49]
  v_pk_add_f32 v[68:69], v[68:69], v[88:89]
  v_pk_add_f32 v[28:29], v[28:29], v[68:69]
  v_pk_add_f32 v[30:31], v[30:31], v[50:51]
  v_pk_add_f32 v[70:71], v[70:71], v[90:91]
  v_pk_add_f32 v[30:31], v[30:31], v[70:71]
  v_pk_add_f32 v[32:33], v[32:33], v[52:53]
  v_pk_add_f32 v[72:73], v[72:73], v[92:93]
  v_pk_add_f32 v[32:33], v[32:33], v[72:73]
  v_pk_add_f32 v[34:35], v[34:35], v[54:55]
  v_pk_add_f32 v[74:75], v[74:75], v[94:95]
  v_pk_add_f32 v[34:35], v[34:35], v[74:75]
  v_cvt_pk_bf16_f32 v36, v16, v17
  v_cvt_pk_bf16_f32 v37, v18, v19
  v_cvt_pk_bf16_f32 v38, v20, v21
  v_cvt_pk_bf16_f32 v39, v22, v23
  v_cvt_pk_bf16_f32 v40, v24, v25
  v_cvt_pk_bf16_f32 v41, v26, v27
  v_cvt_pk_bf16_f32 v42, v28, v29
  v_cvt_pk_bf16_f32 v43, v30, v31
  v_cvt_pk_bf16_f32 v44, v32, v33
  v_cvt_pk_bf16_f32 v45, v34, v35
  s_mov_b32 s16, s40
  s_and_b32 s17, s41, 0xffff
  s_mov_b32 s18, 0x280000
  s_mov_b32 s19, 0x00020000
  buffer_store_dwordx2 v[36:37], v13, s[16:19], s70 offen offset:0
  buffer_store_dwordx2 v[38:39], v13, s[16:19], s70 offen offset:16
  buffer_store_dwordx2 v[40:41], v13, s[16:19], s70 offen offset:32
  buffer_store_dwordx2 v[42:43], v13, s[16:19], s70 offen offset:48
  buffer_store_dwordx2 v[44:45], v13, s[16:19], s71 offen
L_end:
L_exit:
  s_endpgm
.section .rodata,"a"
.p2align 6
.amdhsa_kernel parallel_sum__grouped_kv_mqa__dense_activation_gelu__prompt_kernel
  .amdhsa_next_free_vgpr 256
  .amdhsa_next_free_sgpr 102
  .amdhsa_accum_offset 256
  .amdhsa_group_segment_fixed_size 0
  .amdhsa_kernarg_size 104
  .amdhsa_user_sgpr_count 2
  .amdhsa_user_sgpr_kernarg_segment_ptr 1
  .amdhsa_system_sgpr_workgroup_id_x 1
  .amdhsa_float_denorm_mode_32 3
.end_amdhsa_kernel
```
